```python
import torch

def _softmax(x, axis=-1):
    return torch.softmax(x, dim=axis)
def _gelu(x):
    return torch.nn.functional.gelu(x, approximate="tanh")
def _silu(x):
    return torch.nn.functional.silu(x)
def _sigmoid(x):
    return torch.sigmoid(x)
def _layernorm(x, axis=-1, eps=1e-5):
    m = x.mean(dim=axis, keepdim=True)
    v = x.var(dim=axis, keepdim=True, unbiased=False)
    return (x - m) / torch.sqrt(v + eps)
def _scatter_add(tgt, idx, src, axis=0):
    return tgt.clone().index_add_(axis, idx, src)
def _segment_sum(src, seg, n):
    out = torch.zeros((n,) + src.shape[1:], dtype=src.dtype)
    return out.index_add_(0, seg, src)
def _pad(x, pw):
    flat = tuple(v for pair in reversed(pw) for v in pair)
    return torch.nn.functional.pad(x, flat)

kernel_name = 'standalone__softmax_full_causal__prompt'

def setup_inputs():

    _w = (lambda a: (lambda t: t.to(torch.bfloat16) if t.is_floating_point() else t)(torch.as_tensor(a)))
    B, H, S, D = 1, 32, 2048, 128
    return {
        "q": _w((lambda *s: torch.randn(*s, dtype=torch.bfloat16) * 0.8)(B, H, S, D)),
        "k": _w((lambda *s: torch.randn(*s, dtype=torch.bfloat16) * 0.8)(B, H, S, D)),
        "v": _w((lambda *s: torch.randn(*s, dtype=torch.bfloat16) * 0.05)(B, H, S, D)),
    }

def reference(q, k, v):
    B, H, S, D = q.shape[0], q.shape[1], q.shape[2], q.shape[3]
    scale = D ** -0.5
    scores = torch.einsum('bhqd,bhkd->bhqk', q, k) * scale
    qi = torch.reshape(torch.arange(S), (1, 1, S, 1))
    kj = torch.reshape(torch.arange(S), (1, 1, 1, S))
    causal_bias = (lambda x, dt: x.to(dt))(kj > qi, scores.dtype) * (-1e9)
    attn = _softmax(scores + causal_bias, axis=-1)
    return torch.einsum('bhqk,bhkd->bhqd', attn, v)
```

```asm
; @launch grid=(256,1,1) block=(512,1,1) lds=163840
.amdgcn_target "amdgcn-amd-amdhsa--gfx950"
.text
.globl standalone__softmax_full_causal__prompt_kernel
.p2align 8
.type standalone__softmax_full_causal__prompt_kernel,@function
standalone__softmax_full_causal__prompt_kernel:
    s_cmp_ge_u32 s2, 256
    s_cbranch_scc1 L_END
    s_load_dwordx4 s[4:7], s[0:1], 0
    s_load_dwordx4 s[48:51], s[0:1], 16
    v_lshrrev_b32 v217, 6, v0
    v_and_b32 v223, 63, v0
    v_readfirstlane_b32 s24, v217
    s_and_b32 s52, s2, 7
    s_lshr_b32 s53, s2, 3
    s_and_b32 s54, s53, 3
    s_lshl_b32 s52, s52, 2
    s_add_u32 s52, s52, s54
    s_lshr_b32 s27, s53, 2
    s_lshl_b32 s52, s52, 19
    v_and_b32 v211, 31, v223
    v_lshrrev_b32 v212, 5, v223
    v_and_b32 v213, 15, v223
    v_lshrrev_b32 v214, 4, v223
    s_and_b32 s26, s24, 3
    s_lshl_b32 s30, s27, 7
    s_sub_u32 s29, 1920, s30
    s_lshl_b32 s56, s24, 11
    s_sub_u32 s53, 3, s26
    s_lshl_b32 s53, s53, 5
    s_add_u32 s53, s53, s29
    s_lshl_b32 s57, s53, 8
    v_lshlrev_b32 v217, 8, v211
    v_lshl_add_u32 v224, v212, 4, v217
    s_and_b32 s53, s24, 1
    s_lshl_b32 s53, s53, 3
    v_add_u32 v218, s53, v214
    v_xor_b32 v218, v218, v213
    v_lshlrev_b32 v217, 8, v214
    v_lshl_add_u32 v204, v218, 4, v217
    v_xor_b32 v218, 4, v218
    v_lshl_add_u32 v205, v218, 4, v217
    s_add_u32 s72, s56, 229376
    s_mov_b32 m0, s56
    s_mov_b32 s10, 0x80000
    s_mov_b32 s11, 0x00020000
    s_mov_b32 s14, 0x80000
    s_mov_b32 s15, 0x00020000
    s_mov_b32 s18, 0x80000
    s_mov_b32 s19, 0x00020000
    v_lshlrev_b32 v218, 2, v214
    v_xor_b32 v218, v218, v213
    v_lshl_add_u32 v206, v218, 4, v217
    s_waitcnt lgkmcnt(0)
    s_add_u32 s8, s4, s52
    s_addc_u32 s9, s5, 0
    s_add_u32 s12, s6, s52
    s_addc_u32 s13, s7, 0
    s_add_u32 s16, s48, s52
    s_addc_u32 s17, s49, 0
    buffer_load_dwordx4 v204, s[12:15], s72 offen lds
    buffer_load_dwordx4 v205, s[12:15], s72 offen offset:1024 lds
    s_lshl_b32 s53, s29, 8
    s_add_u32 s53, s53, s56
    s_add_u32 s54, s56, 131072
    s_mov_b32 m0, s54
    s_add_u32 s55, s53, 16384
    buffer_load_dwordx4 v204, s[8:11], s53 offen nt lds
    buffer_load_dwordx4 v205, s[8:11], s53 offen offset:1024 nt lds
    s_add_u32 s54, s54, 16384
    s_mov_b32 m0, s54
    s_nop 0
    buffer_load_dwordx4 v204, s[8:11], s55 offen nt lds
    buffer_load_dwordx4 v205, s[8:11], s55 offen offset:1024 nt lds
    s_add_u32 s54, s56, 0x10000
    s_mov_b32 m0, s54
    s_add_u32 s55, s72, 16384
    buffer_load_dwordx4 v206, s[16:19], s72 offen lds
    buffer_load_dwordx4 v206, s[16:19], s72 offen offset:1024 lds
    s_add_u32 s54, s56, 0x4000
    s_mov_b32 m0, s54
    s_nop 0
    buffer_load_dwordx4 v204, s[12:15], s55 offen lds
    buffer_load_dwordx4 v205, s[12:15], s55 offen offset:1024 lds
    s_add_u32 s20, s50, s52
    s_addc_u32 s21, s51, 0
    s_mov_b32 s22, 0x80000
    s_mov_b32 s23, 0x00020000
    s_lshr_b32 s25, s24, 2
    s_lshl_b32 s28, s27, 1
    s_sub_u32 s31, 34, s28
    s_lshl_b32 s53, s27, 2
    s_sub_u32 s37, 30, s53
    s_lshl_b32 s53, s26, 5
    s_add_u32 s53, s53, s30
    s_lshl_b32 s61, s53, 8
    s_sub_u32 s53, 4, s26
    s_add_u32 s54, s26, 1
    s_cmp_eq_u32 s25, 0
    s_cselect_b32 s58, s53, s54
    s_mov_b32 s32, 2
    s_mov_b32 s33, 1
    s_add_u32 s62, s56, 0x8000
    s_add_u32 s63, s56, 0x14000
    v_bfe_u32 v215, v223, 2, 2
    v_and_b32 v216, 3, v223
    v_lshrrev_b32 v217, 1, v223
    v_lshlrev_b32 v217, 6, v217
    v_sub_u32 v218, 896, v217
    v_add_u32 v217, 960, v217
    v_and_b32 v219, 1, v223
    v_cmp_eq_u32 vcc, 1, v219
    s_nop 1
    v_cndmask_b32 v225, v218, v217, vcc
    v_subrev_u32 v217, s37, v223
    v_lshlrev_b32 v218, 6, v217
    v_cmp_le_i32 vcc, 0, v217
    s_nop 1
    v_cndmask_b32 v225, v225, v218, vcc
    v_subrev_u32 v217, s28, v217
    v_and_b32 v219, 1, v217
    v_mov_b32 v218, s29
    v_mov_b32 v220, s30
    v_cmp_eq_u32 vcc, 1, v219
    s_nop 1
    v_cndmask_b32 v218, v218, v220, vcc
    v_lshrrev_b32 v219, 1, v217
    v_and_b32 v219, 1, v219
    v_lshl_add_u32 v218, v219, 6, v218
    v_cmp_le_i32 vcc, 0, v217
    s_nop 1
    v_cndmask_b32 v225, v225, v218, vcc
    v_lshlrev_b32 v225, 8, v225
    v_add_u32 v225, s56, v225
    s_lshl_b32 s35, s25, 13
    s_mov_b32 s36, s35
    v_lshlrev_b32 v217, 8, v211
    v_add_u32 v217, s35, v217
    v_add_u32 v218, 0, v212
    v_xor_b32 v218, v218, v213
    v_lshl_add_u32 v192, v218, 4, v217
    v_add_u32 v218, 2, v212
    v_xor_b32 v218, v218, v213
    v_lshl_add_u32 v193, v218, 4, v217
    v_add_u32 v218, 4, v212
    v_xor_b32 v218, v218, v213
    v_lshl_add_u32 v194, v218, 4, v217
    v_add_u32 v218, 6, v212
    v_xor_b32 v218, v218, v213
    v_lshl_add_u32 v195, v218, 4, v217
    v_add_u32 v218, 8, v212
    v_xor_b32 v218, v218, v213
    v_lshl_add_u32 v196, v218, 4, v217
    v_add_u32 v218, 10, v212
    v_xor_b32 v218, v218, v213
    v_lshl_add_u32 v197, v218, 4, v217
    v_add_u32 v218, 12, v212
    v_xor_b32 v218, v218, v213
    v_lshl_add_u32 v198, v218, 4, v217
    v_add_u32 v218, 14, v212
    v_xor_b32 v218, v218, v213
    v_lshl_add_u32 v199, v218, 4, v217
    v_lshl_add_u32 v217, v212, 2, v215
    v_lshlrev_b32 v217, 8, v217
    v_add_u32 v217, 65536, v217
    v_add_u32 v217, s36, v217
    v_and_b32 v218, 1, v216
    v_lshl_add_u32 v217, v218, 3, v217
    v_and_b32 v218, 1, v214
    v_lshl_add_u32 v217, v218, 5, v217
    v_lshrrev_b32 v218, 1, v216
    v_lshl_add_u32 v217, v218, 4, v217
    v_xor_b32 v218, 0, v215
    v_lshl_add_u32 v200, v218, 6, v217
    v_xor_b32 v218, 1, v215
    v_lshl_add_u32 v201, v218, 6, v217
    v_xor_b32 v218, 2, v215
    v_lshl_add_u32 v202, v218, 6, v217
    v_xor_b32 v218, 3, v215
    v_lshl_add_u32 v203, v218, 6, v217
    v_lshlrev_b32 v218, 2, v212
    v_sub_u32 v209, v211, v218
    v_mov_b32 v210, 0xff800000
    v_lshlrev_b32 v226, 4, v223
    v_mov_b32 v0, 0
    v_mov_b32 v1, 0
    v_mov_b32 v2, 0
    v_mov_b32 v3, 0
    v_mov_b32 v4, 0
    v_mov_b32 v5, 0
    v_mov_b32 v6, 0
    v_mov_b32 v7, 0
    v_mov_b32 v8, 0
    v_mov_b32 v9, 0
    v_mov_b32 v10, 0
    v_mov_b32 v11, 0
    v_mov_b32 v12, 0
    v_mov_b32 v13, 0
    v_mov_b32 v14, 0
    v_mov_b32 v15, 0
    v_mov_b32 v16, 0
    v_mov_b32 v17, 0
    v_mov_b32 v18, 0
    v_mov_b32 v19, 0
    v_mov_b32 v20, 0
    v_mov_b32 v21, 0
    v_mov_b32 v22, 0
    v_mov_b32 v23, 0
    v_mov_b32 v24, 0
    v_mov_b32 v25, 0
    v_mov_b32 v26, 0
    v_mov_b32 v27, 0
    v_mov_b32 v28, 0
    v_mov_b32 v29, 0
    v_mov_b32 v30, 0
    v_mov_b32 v31, 0
    v_mov_b32 v32, 0
    v_mov_b32 v33, 0
    v_mov_b32 v34, 0
    v_mov_b32 v35, 0
    v_mov_b32 v36, 0
    v_mov_b32 v37, 0
    v_mov_b32 v38, 0
    v_mov_b32 v39, 0
    v_mov_b32 v40, 0
    v_mov_b32 v41, 0
    v_mov_b32 v42, 0
    v_mov_b32 v43, 0
    v_mov_b32 v44, 0
    v_mov_b32 v45, 0
    v_mov_b32 v46, 0
    v_mov_b32 v47, 0
    v_mov_b32 v48, 0
    v_mov_b32 v49, 0
    v_mov_b32 v50, 0
    v_mov_b32 v51, 0
    v_mov_b32 v52, 0
    v_mov_b32 v53, 0
    v_mov_b32 v54, 0
    v_mov_b32 v55, 0
    v_mov_b32 v56, 0
    v_mov_b32 v57, 0
    v_mov_b32 v58, 0
    v_mov_b32 v59, 0
    v_mov_b32 v60, 0
    v_mov_b32 v61, 0
    v_mov_b32 v62, 0
    v_mov_b32 v63, 0
    v_mov_b32 v96, 0
    v_mov_b32 v97, 0
    v_mov_b32 v98, 0
    v_mov_b32 v99, 0
    v_mov_b32 v100, 0
    v_mov_b32 v101, 0
    v_mov_b32 v102, 0
    v_mov_b32 v103, 0
    v_mov_b32 v104, 0
    v_mov_b32 v105, 0
    v_mov_b32 v106, 0
    v_mov_b32 v107, 0
    v_mov_b32 v108, 0
    v_mov_b32 v109, 0
    v_mov_b32 v110, 0
    v_mov_b32 v111, 0
    v_mov_b32 v207, 0
    s_mov_b32 s42, -1.0
    s_mov_b32 s43, 0xff800000
    s_waitcnt vmcnt(4)
    s_barrier
    s_sub_u32 s53, 3, s26
    s_lshl_b32 s53, s53, 13
    s_add_u32 s54, s53, 131072
    s_sub_u32 s54, s54, s35
    v_add_u32 v64, s54, v192
    v_add_u32 v65, s54, v193
    v_add_u32 v66, s54, v194
    v_add_u32 v67, s54, v195
    v_add_u32 v68, s54, v196
    v_add_u32 v69, s54, v197
    v_add_u32 v70, s54, v198
    v_add_u32 v71, s54, v199
    ds_read_b128 v[112:115], v64
    ds_read_b128 v[116:119], v65
    ds_read_b128 v[120:123], v66
    ds_read_b128 v[124:127], v67
    ds_read_b128 v[128:131], v68
    ds_read_b128 v[132:135], v69
    ds_read_b128 v[136:139], v70
    ds_read_b128 v[140:143], v71
    s_mov_b32 s74, 0x3e0293ee
    s_sub_u32 s38, 7, s27
    s_min_u32 s41, s38, 1
    ds_read_b128 v[144:147], v192 offset:0
    ds_read_b128 v[148:151], v193 offset:0
    ds_read_b128 v[152:155], v194 offset:0
    ds_read_b128 v[156:159], v195 offset:0
    ds_read_b128 v[160:163], v196 offset:0
    ds_read_b128 v[164:167], v197 offset:0
    ds_read_b128 v[168:171], v198 offset:0
    ds_read_b128 v[172:175], v199 offset:0
    s_waitcnt lgkmcnt(15)
    v_lshlrev_b32 v211, 16, v112
    v_and_b32 v212, 0xffff0000, v112
    v_mul_f32 v211, s74, v211
    v_mul_f32 v212, s74, v212
    v_cvt_pk_bf16_f32 v112, v211, v212
    v_lshlrev_b32 v213, 16, v113
    v_and_b32 v214, 0xffff0000, v113
    v_mul_f32 v213, s74, v213
    v_mul_f32 v214, s74, v214
    v_cvt_pk_bf16_f32 v113, v213, v214
    v_lshlrev_b32 v215, 16, v114
    v_and_b32 v216, 0xffff0000, v114
    v_mul_f32 v215, s74, v215
    v_mul_f32 v216, s74, v216
    v_cvt_pk_bf16_f32 v114, v215, v216
    v_lshlrev_b32 v217, 16, v115
    v_and_b32 v218, 0xffff0000, v115
    v_mul_f32 v217, s74, v217
    v_mul_f32 v218, s74, v218
    v_cvt_pk_bf16_f32 v115, v217, v218
    s_waitcnt lgkmcnt(6)
    s_nop 0
    v_mfma_f32_32x32x16_bf16 v[64:79], v[144:147], v[112:115], v[96:111]
    s_waitcnt lgkmcnt(14)
    v_lshlrev_b32 v211, 16, v116
    v_and_b32 v212, 0xffff0000, v116
    v_mul_f32 v211, s74, v211
    v_mul_f32 v212, s74, v212
    v_cvt_pk_bf16_f32 v116, v211, v212
    v_lshlrev_b32 v213, 16, v117
    v_and_b32 v214, 0xffff0000, v117
    v_mul_f32 v213, s74, v213
    v_mul_f32 v214, s74, v214
    v_cvt_pk_bf16_f32 v117, v213, v214
    v_lshlrev_b32 v215, 16, v118
    v_and_b32 v216, 0xffff0000, v118
    v_mul_f32 v215, s74, v215
    v_mul_f32 v216, s74, v216
    v_cvt_pk_bf16_f32 v118, v215, v216
    v_lshlrev_b32 v217, 16, v119
    v_and_b32 v218, 0xffff0000, v119
    v_mul_f32 v217, s74, v217
    v_mul_f32 v218, s74, v218
    v_cvt_pk_bf16_f32 v119, v217, v218
    s_nop 1
    v_mfma_f32_32x32x16_bf16 v[64:79], v[148:151], v[116:119], v[64:79]
    v_readlane_b32 s73, v225, s33
    s_cmp_ge_u32 s33, s31
    s_cbranch_scc1 L_skipdma_1
    s_mov_b32 m0, s63
    s_add_u32 s33, s33, 1
    s_add_u32 s63, s63, 0x4000
    s_and_b32 s63, s63, 0xffff
    s_or_b32 s63, s63, 0x10000
    buffer_load_dwordx4 v206, s[16:19], s73 offen lds
    buffer_load_dwordx4 v206, s[16:19], s73 offen offset:1024 lds
L_skipdma_1:
    s_waitcnt lgkmcnt(13)
    v_lshlrev_b32 v211, 16, v120
    v_and_b32 v212, 0xffff0000, v120
    v_mul_f32 v211, s74, v211
    v_mul_f32 v212, s74, v212
    v_cvt_pk_bf16_f32 v120, v211, v212
    v_lshlrev_b32 v213, 16, v121
    v_and_b32 v214, 0xffff0000, v121
    v_mul_f32 v213, s74, v213
    v_mul_f32 v214, s74, v214
    v_cvt_pk_bf16_f32 v121, v213, v214
    v_lshlrev_b32 v215, 16, v122
    v_and_b32 v216, 0xffff0000, v122
    v_mul_f32 v215, s74, v215
    v_mul_f32 v216, s74, v216
    v_cvt_pk_bf16_f32 v122, v215, v216
    v_lshlrev_b32 v217, 16, v123
    v_and_b32 v218, 0xffff0000, v123
    v_mul_f32 v217, s74, v217
    v_mul_f32 v218, s74, v218
    v_cvt_pk_bf16_f32 v123, v217, v218
    s_waitcnt lgkmcnt(4)
    s_nop 0
    v_mfma_f32_32x32x16_bf16 v[64:79], v[152:155], v[120:123], v[64:79]
    s_waitcnt lgkmcnt(12)
    v_lshlrev_b32 v211, 16, v124
    v_and_b32 v212, 0xffff0000, v124
    v_mul_f32 v211, s74, v211
    v_mul_f32 v212, s74, v212
    v_cvt_pk_bf16_f32 v124, v211, v212
    v_lshlrev_b32 v213, 16, v125
    v_and_b32 v214, 0xffff0000, v125
    v_mul_f32 v213, s74, v213
    v_mul_f32 v214, s74, v214
    v_cvt_pk_bf16_f32 v125, v213, v214
    v_lshlrev_b32 v215, 16, v126
    v_and_b32 v216, 0xffff0000, v126
    v_mul_f32 v215, s74, v215
    v_mul_f32 v216, s74, v216
    v_cvt_pk_bf16_f32 v126, v215, v216
    v_lshlrev_b32 v217, 16, v127
    v_and_b32 v218, 0xffff0000, v127
    v_mul_f32 v217, s74, v217
    v_mul_f32 v218, s74, v218
    v_cvt_pk_bf16_f32 v127, v217, v218
    s_nop 1
    v_mfma_f32_32x32x16_bf16 v[64:79], v[156:159], v[124:127], v[64:79]
    v_readlane_b32 s72, v225, s32
    s_cmp_ge_u32 s32, s31
    s_cbranch_scc1 L_skipdma_2
    s_mov_b32 m0, s62
    s_add_u32 s32, s32, 1
    s_add_u32 s62, s62, 0x4000
    s_and_b32 s62, s62, 0xffff
    buffer_load_dwordx4 v204, s[12:15], s72 offen lds
    buffer_load_dwordx4 v205, s[12:15], s72 offen offset:1024 lds
L_skipdma_2:
    s_waitcnt lgkmcnt(11)
    v_lshlrev_b32 v211, 16, v128
    v_and_b32 v212, 0xffff0000, v128
    v_mul_f32 v211, s74, v211
    v_mul_f32 v212, s74, v212
    v_cvt_pk_bf16_f32 v128, v211, v212
    v_lshlrev_b32 v213, 16, v129
    v_and_b32 v214, 0xffff0000, v129
    v_mul_f32 v213, s74, v213
    v_mul_f32 v214, s74, v214
    v_cvt_pk_bf16_f32 v129, v213, v214
    v_lshlrev_b32 v215, 16, v130
    v_and_b32 v216, 0xffff0000, v130
    v_mul_f32 v215, s74, v215
    v_mul_f32 v216, s74, v216
    v_cvt_pk_bf16_f32 v130, v215, v216
    v_lshlrev_b32 v217, 16, v131
    v_and_b32 v218, 0xffff0000, v131
    v_mul_f32 v217, s74, v217
    v_mul_f32 v218, s74, v218
    v_cvt_pk_bf16_f32 v131, v217, v218
    s_waitcnt lgkmcnt(2)
    s_nop 0
    v_mfma_f32_32x32x16_bf16 v[64:79], v[160:163], v[128:131], v[64:79]
    s_waitcnt lgkmcnt(10)
    v_lshlrev_b32 v211, 16, v132
    v_and_b32 v212, 0xffff0000, v132
    v_mul_f32 v211, s74, v211
    v_mul_f32 v212, s74, v212
    v_cvt_pk_bf16_f32 v132, v211, v212
    v_lshlrev_b32 v213, 16, v133
    v_and_b32 v214, 0xffff0000, v133
    v_mul_f32 v213, s74, v213
    v_mul_f32 v214, s74, v214
    v_cvt_pk_bf16_f32 v133, v213, v214
    v_lshlrev_b32 v215, 16, v134
    v_and_b32 v216, 0xffff0000, v134
    v_mul_f32 v215, s74, v215
    v_mul_f32 v216, s74, v216
    v_cvt_pk_bf16_f32 v134, v215, v216
    v_lshlrev_b32 v217, 16, v135
    v_and_b32 v218, 0xffff0000, v135
    v_mul_f32 v217, s74, v217
    v_mul_f32 v218, s74, v218
    v_cvt_pk_bf16_f32 v135, v217, v218
    s_nop 1
    v_mfma_f32_32x32x16_bf16 v[64:79], v[164:167], v[132:135], v[64:79]
    v_readlane_b32 s73, v225, s33
    s_cmp_ge_u32 s33, s31
    s_cbranch_scc1 L_skipdma_3
    s_mov_b32 m0, s63
    s_add_u32 s33, s33, 1
    s_add_u32 s63, s63, 0x4000
    s_and_b32 s63, s63, 0xffff
    s_or_b32 s63, s63, 0x10000
    buffer_load_dwordx4 v206, s[16:19], s73 offen lds
    buffer_load_dwordx4 v206, s[16:19], s73 offen offset:1024 lds
L_skipdma_3:
    s_waitcnt lgkmcnt(9)
    v_lshlrev_b32 v211, 16, v136
    v_and_b32 v212, 0xffff0000, v136
    v_mul_f32 v211, s74, v211
    v_mul_f32 v212, s74, v212
    v_cvt_pk_bf16_f32 v136, v211, v212
    v_lshlrev_b32 v213, 16, v137
    v_and_b32 v214, 0xffff0000, v137
    v_mul_f32 v213, s74, v213
    v_mul_f32 v214, s74, v214
    v_cvt_pk_bf16_f32 v137, v213, v214
    v_lshlrev_b32 v215, 16, v138
    v_and_b32 v216, 0xffff0000, v138
    v_mul_f32 v215, s74, v215
    v_mul_f32 v216, s74, v216
    v_cvt_pk_bf16_f32 v138, v215, v216
    v_lshlrev_b32 v217, 16, v139
    v_and_b32 v218, 0xffff0000, v139
    v_mul_f32 v217, s74, v217
    v_mul_f32 v218, s74, v218
    v_cvt_pk_bf16_f32 v139, v217, v218
    s_waitcnt lgkmcnt(0)
    s_nop 0
    v_mfma_f32_32x32x16_bf16 v[64:79], v[168:171], v[136:139], v[64:79]
    s_waitcnt lgkmcnt(8)
    v_lshlrev_b32 v211, 16, v140
    v_and_b32 v212, 0xffff0000, v140
    v_mul_f32 v211, s74, v211
    v_mul_f32 v212, s74, v212
    v_cvt_pk_bf16_f32 v140, v211, v212
    v_lshlrev_b32 v213, 16, v141
    v_and_b32 v214, 0xffff0000, v141
    v_mul_f32 v213, s74, v213
    v_mul_f32 v214, s74, v214
    v_cvt_pk_bf16_f32 v141, v213, v214
    v_lshlrev_b32 v215, 16, v142
    v_and_b32 v216, 0xffff0000, v142
    v_mul_f32 v215, s74, v215
    v_mul_f32 v216, s74, v216
    v_cvt_pk_bf16_f32 v142, v215, v216
    v_lshlrev_b32 v217, 16, v143
    v_and_b32 v218, 0xffff0000, v143
    v_mul_f32 v217, s74, v217
    v_mul_f32 v218, s74, v218
    v_cvt_pk_bf16_f32 v143, v217, v218
    s_nop 1
    v_mfma_f32_32x32x16_bf16 v[64:79], v[172:175], v[140:143], v[64:79]
    v_readlane_b32 s72, v225, s32
    s_cmp_ge_u32 s32, s31
    s_cbranch_scc1 L_skipdma_4
    s_mov_b32 m0, s62
    s_add_u32 s32, s32, 1
    s_add_u32 s62, s62, 0x4000
    s_and_b32 s62, s62, 0xffff
    buffer_load_dwordx4 v204, s[12:15], s72 offen lds
    buffer_load_dwordx4 v205, s[12:15], s72 offen offset:1024 lds
L_skipdma_4:
    s_nop 2
    v_max3_f32 v211, v64, v65, v66
    v_max3_f32 v211, v211, v67, v68
    v_max3_f32 v211, v211, v69, v70
    v_max3_f32 v211, v211, v71, v72
    v_max3_f32 v211, v211, v73, v74
    v_max3_f32 v211, v211, v75, v76
    v_max3_f32 v211, v211, v77, v78
    v_max_f32 v211, v211, v79
    v_mov_b32 v212, v211
    s_nop 1
    v_permlane32_swap_b32 v211, v212
    v_max_f32 v213, v211, v212
    v_sub_f32 v64, v64, v213
    v_sub_f32 v65, v65, v213
    v_sub_f32 v66, v66, v213
    v_sub_f32 v67, v67, v213
    v_sub_f32 v68, v68, v213
    v_sub_f32 v69, v69, v213
    v_sub_f32 v70, v70, v213
    v_sub_f32 v71, v71, v213
    v_sub_f32 v72, v72, v213
    v_sub_f32 v73, v73, v213
    v_sub_f32 v74, v74, v213
    v_sub_f32 v75, v75, v213
    v_sub_f32 v76, v76, v213
    v_sub_f32 v77, v77, v213
    v_sub_f32 v78, v78, v213
    v_sub_f32 v79, v79, v213
    v_sub_f32 v96, 0, v213
    v_sub_f32 v97, 0, v213
    v_sub_f32 v98, 0, v213
    v_sub_f32 v99, 0, v213
    v_sub_f32 v100, 0, v213
    v_sub_f32 v101, 0, v213
    v_sub_f32 v102, 0, v213
    v_sub_f32 v103, 0, v213
    v_sub_f32 v104, 0, v213
    v_sub_f32 v105, 0, v213
    v_sub_f32 v106, 0, v213
    v_sub_f32 v107, 0, v213
    v_sub_f32 v108, 0, v213
    v_sub_f32 v109, 0, v213
    v_sub_f32 v110, 0, v213
    v_sub_f32 v111, 0, v213
    s_mov_b32 s42, 0x43800000
    s_mov_b32 s43, 0
    v_readlane_b32 s72, v225, s32
    v_readlane_b32 s73, v225, s33
    s_cmp_lg_u32 s25, 0
    s_cbranch_scc1 L_S_PRE_Y
L_S_FIRST_X:
    s_waitcnt vmcnt(8) lgkmcnt(0)
    s_barrier
    ds_read_b128 v[144:147], v192 offset:16384
    ds_read_b128 v[148:151], v193 offset:16384
    ds_read_b128 v[152:155], v194 offset:16384
    ds_read_b128 v[156:159], v195 offset:16384
    ds_read_b128 v[160:163], v196 offset:16384
    ds_read_b128 v[164:167], v197 offset:16384
    ds_read_b128 v[168:171], v198 offset:16384
    ds_read_b128 v[172:175], v199 offset:16384
    s_mov_b32 m0, s62
    s_add_u32 s62, s62, 0x4000
    buffer_load_dwordx4 v204, s[12:15], s72 offen lds
    s_and_b32 s62, s62, 0xffff
    buffer_load_dwordx4 v205, s[12:15], s72 offen offset:1024 lds
    v_exp_f32 v184, v64
    v_exp_f32 v185, v65
    s_mov_b32 m0, s63
    s_add_u32 s63, s63, 0x4000
    buffer_load_dwordx4 v206, s[16:19], s73 offen lds
    v_exp_f32 v186, v66
    v_exp_f32 v187, v67
    v_add_f32 v208, v184, v185
    s_and_b32 s63, s63, 0xffff
    buffer_load_dwordx4 v206, s[16:19], s73 offen offset:1024 lds
    v_exp_f32 v188, v68
    v_exp_f32 v189, v69
    v_add_f32 v208, v208, v186
    v_cvt_pk_bf16_f32 v176, v184, v185
    s_or_b32 s63, s63, 0x10000
    s_add_u32 s32, s32, 1
    v_exp_f32 v190, v70
    v_exp_f32 v191, v71
    v_add_f32 v208, v208, v187
    v_cvt_pk_bf16_f32 v177, v186, v187
    s_add_u32 s33, s33, 1
    v_readlane_b32 s72, v225, s32
    v_exp_f32 v184, v72
    v_add_f32 v208, v208, v188
    v_add_f32 v208, v208, v189
    v_cvt_pk_bf16_f32 v178, v188, v189
    v_readlane_b32 s73, v225, s33
    v_exp_f32 v185, v73
    v_add_f32 v208, v208, v190
    v_add_f32 v208, v208, v191
    v_cvt_pk_bf16_f32 v179, v190, v191
    v_exp_f32 v186, v74
    v_add_f32 v208, v208, v184
    s_waitcnt lgkmcnt(6)
    v_mfma_f32_32x32x16_bf16 v[80:95], v[144:147], v[112:115], v[96:111]
    ds_read_b64_tr_b16 v[144:145], v200 offset:0
    ds_read_b64_tr_b16 v[146:147], v200 offset:2048
    v_exp_f32 v187, v75
    v_add_f32 v208, v208, v185
    v_cvt_pk_bf16_f32 v180, v184, v185
    v_mfma_f32_32x32x16_bf16 v[80:95], v[148:151], v[116:119], v[80:95]
    ds_read_b64_tr_b16 v[148:149], v201 offset:0
    ds_read_b64_tr_b16 v[150:151], v201 offset:2048
    v_exp_f32 v188, v76
    v_add_f32 v208, v208, v186
    s_waitcnt lgkmcnt(8)
    v_mfma_f32_32x32x16_bf16 v[80:95], v[152:155], v[120:123], v[80:95]
    ds_read_b64_tr_b16 v[152:153], v202 offset:0
    ds_read_b64_tr_b16 v[154:155], v202 offset:2048
    v_exp_f32 v189, v77
    v_add_f32 v208, v208, v187
    v_cvt_pk_bf16_f32 v181, v186, v187
    v_mfma_f32_32x32x16_bf16 v[80:95], v[156:159], v[124:127], v[80:95]
    ds_read_b64_tr_b16 v[156:157], v203 offset:0
    ds_read_b64_tr_b16 v[158:159], v203 offset:2048
    v_exp_f32 v190, v78
    v_add_f32 v208, v208, v188
    s_waitcnt lgkmcnt(10)
    v_mfma_f32_32x32x16_bf16 v[80:95], v[160:163], v[128:131], v[80:95]
    ds_read_b64_tr_b16 v[160:161], v200 offset:4096
    ds_read_b64_tr_b16 v[162:163], v200 offset:6144
    v_exp_f32 v191, v79
    v_add_f32 v208, v208, v189
    v_cvt_pk_bf16_f32 v182, v188, v189
    v_mfma_f32_32x32x16_bf16 v[80:95], v[164:167], v[132:135], v[80:95]
    ds_read_b64_tr_b16 v[164:165], v201 offset:4096
    ds_read_b64_tr_b16 v[166:167], v201 offset:6144
    v_add_f32 v208, v208, v190
    s_waitcnt lgkmcnt(12)
    v_mfma_f32_32x32x16_bf16 v[80:95], v[168:171], v[136:139], v[80:95]
    ds_read_b64_tr_b16 v[168:169], v202 offset:4096
    ds_read_b64_tr_b16 v[170:171], v202 offset:6144
    v_add_f32 v208, v208, v191
    v_cvt_pk_bf16_f32 v183, v190, v191
    v_mfma_f32_32x32x16_bf16 v[80:95], v[172:175], v[140:143], v[80:95]
    ds_read_b64_tr_b16 v[172:173], v203 offset:4096
    ds_read_b64_tr_b16 v[174:175], v203 offset:6144
    v_cmp_lt_f32 vcc, s42, v208
    s_cbranch_vccnz L_rare_5
L_back_6:
    v_add_f32 v207, v207, v208
L_S_LOOP_X:
    s_cmp_gt_u32 s38, 1
    s_cbranch_scc1 L_S_GO_X
    s_cmp_eq_u32 s38, s41
    s_cbranch_scc0 L_S_NOQB_X
    s_lshl_b32 s53, s30, 8
    s_add_u32 s53, s53, s56
    s_add_u32 s54, s56, 131072
    s_mov_b32 m0, s54
    s_nop 0
    buffer_load_dwordx4 v204, s[8:11], s53 offen nt lds
    buffer_load_dwordx4 v205, s[8:11], s53 offen offset:1024 nt lds
    s_lshl_b32 s53, s30, 8
    s_add_u32 s53, s53, s56
    s_add_u32 s53, s53, 16384
    s_add_u32 s54, s56, 147456
    s_mov_b32 m0, s54
    s_nop 0
    buffer_load_dwordx4 v204, s[8:11], s53 offen nt lds
    buffer_load_dwordx4 v205, s[8:11], s53 offen offset:1024 nt lds
L_S_NOQB_X:
    s_cmp_eq_u32 s38, 0
    s_cbranch_scc1 L_S_LAST_X
L_S_GO_X:
    s_sub_u32 s38, s38, 1
L_S_MID1_X:
    s_waitcnt vmcnt(8) lgkmcnt(0)
    s_barrier
    v_mfma_f32_32x32x16_bf16 v[0:15], v[144:147], v[176:179], v[0:15]
    ds_read_b128 v[144:147], v192 offset:32768
    s_mov_b32 m0, s62
    s_add_u32 s62, s62, 0x4000
    buffer_load_dwordx4 v204, s[12:15], s72 offen lds
    v_mfma_f32_32x32x16_bf16 v[16:31], v[148:151], v[176:179], v[16:31]
    ds_read_b128 v[148:151], v193 offset:32768
    s_and_b32 s62, s62, 0xffff
    buffer_load_dwordx4 v205, s[12:15], s72 offen offset:1024 lds
    v_exp_f32 v184, v80
    v_exp_f32 v185, v81
    v_mfma_f32_32x32x16_bf16 v[32:47], v[152:155], v[176:179], v[32:47]
    ds_read_b128 v[152:155], v194 offset:32768
    s_mov_b32 m0, s63
    s_add_u32 s63, s63, 0x4000
    buffer_load_dwordx4 v206, s[16:19], s73 offen lds
    v_exp_f32 v186, v82
    v_exp_f32 v187, v83
    v_add_f32 v208, v184, v185
    v_mfma_f32_32x32x16_bf16 v[48:63], v[156:159], v[176:179], v[48:63]
    ds_read_b128 v[156:159], v195 offset:32768
    s_and_b32 s63, s63, 0xffff
    buffer_load_dwordx4 v206, s[16:19], s73 offen offset:1024 lds
    v_exp_f32 v188, v84
    v_exp_f32 v189, v85
    v_add_f32 v208, v208, v186
    v_cvt_pk_bf16_f32 v176, v184, v185
    v_mfma_f32_32x32x16_bf16 v[0:15], v[160:163], v[180:183], v[0:15]
    ds_read_b128 v[160:163], v196 offset:32768
    s_or_b32 s63, s63, 0x10000
    s_add_u32 s32, s32, 1
    v_exp_f32 v190, v86
    v_exp_f32 v191, v87
    v_add_f32 v208, v208, v187
    v_cvt_pk_bf16_f32 v177, v186, v187
    v_mfma_f32_32x32x16_bf16 v[16:31], v[164:167], v[180:183], v[16:31]
    ds_read_b128 v[164:167], v197 offset:32768
    s_add_u32 s33, s33, 1
    v_readlane_b32 s72, v225, s32
    v_exp_f32 v184, v88
    v_add_f32 v208, v208, v188
    v_add_f32 v208, v208, v189
    v_cvt_pk_bf16_f32 v178, v188, v189
    v_mfma_f32_32x32x16_bf16 v[32:47], v[168:171], v[180:183], v[32:47]
    ds_read_b128 v[168:171], v198 offset:32768
    v_readlane_b32 s73, v225, s33
    v_exp_f32 v185, v89
    v_add_f32 v208, v208, v190
    v_add_f32 v208, v208, v191
    v_cvt_pk_bf16_f32 v179, v190, v191
    v_mfma_f32_32x32x16_bf16 v[48:63], v[172:175], v[180:183], v[48:63]
    ds_read_b128 v[172:175], v199 offset:32768
    v_exp_f32 v186, v90
    v_add_f32 v208, v208, v184
    s_waitcnt lgkmcnt(6)
    v_mfma_f32_32x32x16_bf16 v[64:79], v[144:147], v[112:115], v[96:111]
    ds_read_b64_tr_b16 v[144:145], v200 offset:16384
    ds_read_b64_tr_b16 v[146:147], v200 offset:18432
    v_exp_f32 v187, v91
    v_add_f32 v208, v208, v185
    v_cvt_pk_bf16_f32 v180, v184, v185
    v_mfma_f32_32x32x16_bf16 v[64:79], v[148:151], v[116:119], v[64:79]
    ds_read_b64_tr_b16 v[148:149], v201 offset:16384
    ds_read_b64_tr_b16 v[150:151], v201 offset:18432
    v_exp_f32 v188, v92
    v_add_f32 v208, v208, v186
    s_waitcnt lgkmcnt(8)
    v_mfma_f32_32x32x16_bf16 v[64:79], v[152:155], v[120:123], v[64:79]
    ds_read_b64_tr_b16 v[152:153], v202 offset:16384
    ds_read_b64_tr_b16 v[154:155], v202 offset:18432
    v_exp_f32 v189, v93
    v_add_f32 v208, v208, v187
    v_cvt_pk_bf16_f32 v181, v186, v187
    v_mfma_f32_32x32x16_bf16 v[64:79], v[156:159], v[124:127], v[64:79]
    ds_read_b64_tr_b16 v[156:157], v203 offset:16384
    ds_read_b64_tr_b16 v[158:159], v203 offset:18432
    v_exp_f32 v190, v94
    v_add_f32 v208, v208, v188
    s_waitcnt lgkmcnt(10)
    v_mfma_f32_32x32x16_bf16 v[64:79], v[160:163], v[128:131], v[64:79]
    ds_read_b64_tr_b16 v[160:161], v200 offset:20480
    ds_read_b64_tr_b16 v[162:163], v200 offset:22528
    v_exp_f32 v191, v95
    v_add_f32 v208, v208, v189
    v_cvt_pk_bf16_f32 v182, v188, v189
    v_mfma_f32_32x32x16_bf16 v[64:79], v[164:167], v[132:135], v[64:79]
    ds_read_b64_tr_b16 v[164:165], v201 offset:20480
    ds_read_b64_tr_b16 v[166:167], v201 offset:22528
    v_add_f32 v208, v208, v190
    s_waitcnt lgkmcnt(12)
    v_mfma_f32_32x32x16_bf16 v[64:79], v[168:171], v[136:139], v[64:79]
    ds_read_b64_tr_b16 v[168:169], v202 offset:20480
    ds_read_b64_tr_b16 v[170:171], v202 offset:22528
    v_add_f32 v208, v208, v191
    v_cvt_pk_bf16_f32 v183, v190, v191
    v_mfma_f32_32x32x16_bf16 v[64:79], v[172:175], v[140:143], v[64:79]
    ds_read_b64_tr_b16 v[172:173], v203 offset:20480
    ds_read_b64_tr_b16 v[174:175], v203 offset:22528
    v_cmp_lt_f32 vcc, s42, v208
    s_cbranch_vccnz L_rare_7
L_back_8:
    v_add_f32 v207, v207, v208
L_S_MID2_X:
    s_waitcnt vmcnt(8) lgkmcnt(0)
    s_barrier
    v_mfma_f32_32x32x16_bf16 v[0:15], v[144:147], v[176:179], v[0:15]
    ds_read_b128 v[144:147], v192 offset:49152
    s_mov_b32 m0, s62
    s_add_u32 s62, s62, 0x4000
    buffer_load_dwordx4 v204, s[12:15], s72 offen lds
    v_mfma_f32_32x32x16_bf16 v[16:31], v[148:151], v[176:179], v[16:31]
    ds_read_b128 v[148:151], v193 offset:49152
    s_and_b32 s62, s62, 0xffff
    buffer_load_dwordx4 v205, s[12:15], s72 offen offset:1024 lds
    v_exp_f32 v184, v64
    v_exp_f32 v185, v65
    v_mfma_f32_32x32x16_bf16 v[32:47], v[152:155], v[176:179], v[32:47]
    ds_read_b128 v[152:155], v194 offset:49152
    s_mov_b32 m0, s63
    s_add_u32 s63, s63, 0x4000
    buffer_load_dwordx4 v206, s[16:19], s73 offen lds
    v_exp_f32 v186, v66
    v_exp_f32 v187, v67
    v_add_f32 v208, v184, v185
    v_mfma_f32_32x32x16_bf16 v[48:63], v[156:159], v[176:179], v[48:63]
    ds_read_b128 v[156:159], v195 offset:49152
    s_and_b32 s63, s63, 0xffff
    buffer_load_dwordx4 v206, s[16:19], s73 offen offset:1024 lds
    v_exp_f32 v188, v68
    v_exp_f32 v189, v69
    v_add_f32 v208, v208, v186
    v_cvt_pk_bf16_f32 v176, v184, v185
    v_mfma_f32_32x32x16_bf16 v[0:15], v[160:163], v[180:183], v[0:15]
    ds_read_b128 v[160:163], v196 offset:49152
    s_or_b32 s63, s63, 0x10000
    s_add_u32 s32, s32, 1
    v_exp_f32 v190, v70
    v_exp_f32 v191, v71
    v_add_f32 v208, v208, v187
    v_cvt_pk_bf16_f32 v177, v186, v187
    v_mfma_f32_32x32x16_bf16 v[16:31], v[164:167], v[180:183], v[16:31]
    ds_read_b128 v[164:167], v197 offset:49152
    s_add_u32 s33, s33, 1
    v_readlane_b32 s72, v225, s32
    v_exp_f32 v184, v72
    v_add_f32 v208, v208, v188
    v_add_f32 v208, v208, v189
    v_cvt_pk_bf16_f32 v178, v188, v189
    v_mfma_f32_32x32x16_bf16 v[32:47], v[168:171], v[180:183], v[32:47]
    ds_read_b128 v[168:171], v198 offset:49152
    v_readlane_b32 s73, v225, s33
    v_exp_f32 v185, v73
    v_add_f32 v208, v208, v190
    v_add_f32 v208, v208, v191
    v_cvt_pk_bf16_f32 v179, v190, v191
    v_mfma_f32_32x32x16_bf16 v[48:63], v[172:175], v[180:183], v[48:63]
    ds_read_b128 v[172:175], v199 offset:49152
    v_exp_f32 v186, v74
    v_add_f32 v208, v208, v184
    s_waitcnt lgkmcnt(6)
    v_mfma_f32_32x32x16_bf16 v[80:95], v[144:147], v[112:115], v[96:111]
    ds_read_b64_tr_b16 v[144:145], v200 offset:32768
    ds_read_b64_tr_b16 v[146:147], v200 offset:34816
    v_exp_f32 v187, v75
    v_add_f32 v208, v208, v185
    v_cvt_pk_bf16_f32 v180, v184, v185
    v_mfma_f32_32x32x16_bf16 v[80:95], v[148:151], v[116:119], v[80:95]
    ds_read_b64_tr_b16 v[148:149], v201 offset:32768
    ds_read_b64_tr_b16 v[150:151], v201 offset:34816
    v_exp_f32 v188, v76
    v_add_f32 v208, v208, v186
    s_waitcnt lgkmcnt(8)
    v_mfma_f32_32x32x16_bf16 v[80:95], v[152:155], v[120:123], v[80:95]
    ds_read_b64_tr_b16 v[152:153], v202 offset:32768
    ds_read_b64_tr_b16 v[154:155], v202 offset:34816
    v_exp_f32 v189, v77
    v_add_f32 v208, v208, v187
    v_cvt_pk_bf16_f32 v181, v186, v187
    v_mfma_f32_32x32x16_bf16 v[80:95], v[156:159], v[124:127], v[80:95]
    ds_read_b64_tr_b16 v[156:157], v203 offset:32768
    ds_read_b64_tr_b16 v[158:159], v203 offset:34816
    v_exp_f32 v190, v78
    v_add_f32 v208, v208, v188
    s_waitcnt lgkmcnt(10)
    v_mfma_f32_32x32x16_bf16 v[80:95], v[160:163], v[128:131], v[80:95]
    ds_read_b64_tr_b16 v[160:161], v200 offset:36864
    ds_read_b64_tr_b16 v[162:163], v200 offset:38912
    v_exp_f32 v191, v79
    v_add_f32 v208, v208, v189
    v_cvt_pk_bf16_f32 v182, v188, v189
    v_mfma_f32_32x32x16_bf16 v[80:95], v[164:167], v[132:135], v[80:95]
    ds_read_b64_tr_b16 v[164:165], v201 offset:36864
    ds_read_b64_tr_b16 v[166:167], v201 offset:38912
    v_add_f32 v208, v208, v190
    s_waitcnt lgkmcnt(12)
    v_mfma_f32_32x32x16_bf16 v[80:95], v[168:171], v[136:139], v[80:95]
    ds_read_b64_tr_b16 v[168:169], v202 offset:36864
    ds_read_b64_tr_b16 v[170:171], v202 offset:38912
    v_add_f32 v208, v208, v191
    v_cvt_pk_bf16_f32 v183, v190, v191
    v_mfma_f32_32x32x16_bf16 v[80:95], v[172:175], v[140:143], v[80:95]
    ds_read_b64_tr_b16 v[172:173], v203 offset:36864
    ds_read_b64_tr_b16 v[174:175], v203 offset:38912
    v_cmp_lt_f32 vcc, s42, v208
    s_cbranch_vccnz L_rare_9
L_back_10:
    v_add_f32 v207, v207, v208
L_S_MID3_X:
    s_waitcnt vmcnt(8) lgkmcnt(0)
    s_barrier
    v_mfma_f32_32x32x16_bf16 v[0:15], v[144:147], v[176:179], v[0:15]
    ds_read_b128 v[144:147], v192 offset:0
    s_mov_b32 m0, s62
    s_add_u32 s62, s62, 0x4000
    buffer_load_dwordx4 v204, s[12:15], s72 offen lds
    v_mfma_f32_32x32x16_bf16 v[16:31], v[148:151], v[176:179], v[16:31]
    ds_read_b128 v[148:151], v193 offset:0
    s_and_b32 s62, s62, 0xffff
    buffer_load_dwordx4 v205, s[12:15], s72 offen offset:1024 lds
    v_exp_f32 v184, v80
    v_exp_f32 v185, v81
    v_mfma_f32_32x32x16_bf16 v[32:47], v[152:155], v[176:179], v[32:47]
    ds_read_b128 v[152:155], v194 offset:0
    s_mov_b32 m0, s63
    s_add_u32 s63, s63, 0x4000
    buffer_load_dwordx4 v206, s[16:19], s73 offen lds
    v_exp_f32 v186, v82
    v_exp_f32 v187, v83
    v_add_f32 v208, v184, v185
    v_mfma_f32_32x32x16_bf16 v[48:63], v[156:159], v[176:179], v[48:63]
    ds_read_b128 v[156:159], v195 offset:0
    s_and_b32 s63, s63, 0xffff
    buffer_load_dwordx4 v206, s[16:19], s73 offen offset:1024 lds
    v_exp_f32 v188, v84
    v_exp_f32 v189, v85
    v_add_f32 v208, v208, v186
    v_cvt_pk_bf16_f32 v176, v184, v185
    v_mfma_f32_32x32x16_bf16 v[0:15], v[160:163], v[180:183], v[0:15]
    ds_read_b128 v[160:163], v196 offset:0
    s_or_b32 s63, s63, 0x10000
    s_add_u32 s32, s32, 1
    v_exp_f32 v190, v86
    v_exp_f32 v191, v87
    v_add_f32 v208, v208, v187
    v_cvt_pk_bf16_f32 v177, v186, v187
    v_mfma_f32_32x32x16_bf16 v[16:31], v[164:167], v[180:183], v[16:31]
    ds_read_b128 v[164:167], v197 offset:0
    s_add_u32 s33, s33, 1
    v_readlane_b32 s72, v225, s32
    v_exp_f32 v184, v88
    v_add_f32 v208, v208, v188
    v_add_f32 v208, v208, v189
    v_cvt_pk_bf16_f32 v178, v188, v189
    v_mfma_f32_32x32x16_bf16 v[32:47], v[168:171], v[180:183], v[32:47]
    ds_read_b128 v[168:171], v198 offset:0
    v_readlane_b32 s73, v225, s33
    v_exp_f32 v185, v89
    v_add_f32 v208, v208, v190
    v_add_f32 v208, v208, v191
    v_cvt_pk_bf16_f32 v179, v190, v191
    v_mfma_f32_32x32x16_bf16 v[48:63], v[172:175], v[180:183], v[48:63]
    ds_read_b128 v[172:175], v199 offset:0
    v_exp_f32 v186, v90
    v_add_f32 v208, v208, v184
    s_waitcnt lgkmcnt(6)
    v_mfma_f32_32x32x16_bf16 v[64:79], v[144:147], v[112:115], v[96:111]
    ds_read_b64_tr_b16 v[144:145], v200 offset:49152
    ds_read_b64_tr_b16 v[146:147], v200 offset:51200
    v_exp_f32 v187, v91
    v_add_f32 v208, v208, v185
    v_cvt_pk_bf16_f32 v180, v184, v185
    v_mfma_f32_32x32x16_bf16 v[64:79], v[148:151], v[116:119], v[64:79]
    ds_read_b64_tr_b16 v[148:149], v201 offset:49152
    ds_read_b64_tr_b16 v[150:151], v201 offset:51200
    v_exp_f32 v188, v92
    v_add_f32 v208, v208, v186
    s_waitcnt lgkmcnt(8)
    v_mfma_f32_32x32x16_bf16 v[64:79], v[152:155], v[120:123], v[64:79]
    ds_read_b64_tr_b16 v[152:153], v202 offset:49152
    ds_read_b64_tr_b16 v[154:155], v202 offset:51200
    v_exp_f32 v189, v93
    v_add_f32 v208, v208, v187
    v_cvt_pk_bf16_f32 v181, v186, v187
    v_mfma_f32_32x32x16_bf16 v[64:79], v[156:159], v[124:127], v[64:79]
    ds_read_b64_tr_b16 v[156:157], v203 offset:49152
    ds_read_b64_tr_b16 v[158:159], v203 offset:51200
    v_exp_f32 v190, v94
    v_add_f32 v208, v208, v188
    s_waitcnt lgkmcnt(10)
    v_mfma_f32_32x32x16_bf16 v[64:79], v[160:163], v[128:131], v[64:79]
    ds_read_b64_tr_b16 v[160:161], v200 offset:53248
    ds_read_b64_tr_b16 v[162:163], v200 offset:55296
    v_exp_f32 v191, v95
    v_add_f32 v208, v208, v189
    v_cvt_pk_bf16_f32 v182, v188, v189
    v_mfma_f32_32x32x16_bf16 v[64:79], v[164:167], v[132:135], v[64:79]
    ds_read_b64_tr_b16 v[164:165], v201 offset:53248
    ds_read_b64_tr_b16 v[166:167], v201 offset:55296
    v_add_f32 v208, v208, v190
    s_waitcnt lgkmcnt(12)
    v_mfma_f32_32x32x16_bf16 v[64:79], v[168:171], v[136:139], v[64:79]
    ds_read_b64_tr_b16 v[168:169], v202 offset:53248
    ds_read_b64_tr_b16 v[170:171], v202 offset:55296
    v_add_f32 v208, v208, v191
    v_cvt_pk_bf16_f32 v183, v190, v191
    v_mfma_f32_32x32x16_bf16 v[64:79], v[172:175], v[140:143], v[64:79]
    ds_read_b64_tr_b16 v[172:173], v203 offset:53248
    ds_read_b64_tr_b16 v[174:175], v203 offset:55296
    v_cmp_lt_f32 vcc, s42, v208
    s_cbranch_vccnz L_rare_11
L_back_12:
    v_add_f32 v207, v207, v208
L_S_MID0_X:
    s_waitcnt vmcnt(8) lgkmcnt(0)
    s_barrier
    v_mfma_f32_32x32x16_bf16 v[0:15], v[144:147], v[176:179], v[0:15]
    ds_read_b128 v[144:147], v192 offset:16384
    s_mov_b32 m0, s62
    s_add_u32 s62, s62, 0x4000
    buffer_load_dwordx4 v204, s[12:15], s72 offen lds
    v_mfma_f32_32x32x16_bf16 v[16:31], v[148:151], v[176:179], v[16:31]
    ds_read_b128 v[148:151], v193 offset:16384
    s_and_b32 s62, s62, 0xffff
    buffer_load_dwordx4 v205, s[12:15], s72 offen offset:1024 lds
    v_exp_f32 v184, v64
    v_exp_f32 v185, v65
    v_mfma_f32_32x32x16_bf16 v[32:47], v[152:155], v[176:179], v[32:47]
    ds_read_b128 v[152:155], v194 offset:16384
    s_mov_b32 m0, s63
    s_add_u32 s63, s63, 0x4000
    buffer_load_dwordx4 v206, s[16:19], s73 offen lds
    v_exp_f32 v186, v66
    v_exp_f32 v187, v67
    v_add_f32 v208, v184, v185
    v_mfma_f32_32x32x16_bf16 v[48:63], v[156:159], v[176:179], v[48:63]
    ds_read_b128 v[156:159], v195 offset:16384
    s_and_b32 s63, s63, 0xffff
    buffer_load_dwordx4 v206, s[16:19], s73 offen offset:1024 lds
    v_exp_f32 v188, v68
    v_exp_f32 v189, v69
    v_add_f32 v208, v208, v186
    v_cvt_pk_bf16_f32 v176, v184, v185
    v_mfma_f32_32x32x16_bf16 v[0:15], v[160:163], v[180:183], v[0:15]
    ds_read_b128 v[160:163], v196 offset:16384
    s_or_b32 s63, s63, 0x10000
    s_add_u32 s32, s32, 1
    v_exp_f32 v190, v70
    v_exp_f32 v191, v71
    v_add_f32 v208, v208, v187
    v_cvt_pk_bf16_f32 v177, v186, v187
    v_mfma_f32_32x32x16_bf16 v[16:31], v[164:167], v[180:183], v[16:31]
    ds_read_b128 v[164:167], v197 offset:16384
    s_add_u32 s33, s33, 1
    v_readlane_b32 s72, v225, s32
    v_exp_f32 v184, v72
    v_add_f32 v208, v208, v188
    v_add_f32 v208, v208, v189
    v_cvt_pk_bf16_f32 v178, v188, v189
    v_mfma_f32_32x32x16_bf16 v[32:47], v[168:171], v[180:183], v[32:47]
    ds_read_b128 v[168:171], v198 offset:16384
    v_readlane_b32 s73, v225, s33
    v_exp_f32 v185, v73
    v_add_f32 v208, v208, v190
    v_add_f32 v208, v208, v191
    v_cvt_pk_bf16_f32 v179, v190, v191
    v_mfma_f32_32x32x16_bf16 v[48:63], v[172:175], v[180:183], v[48:63]
    ds_read_b128 v[172:175], v199 offset:16384
    v_exp_f32 v186, v74
    v_add_f32 v208, v208, v184
    s_waitcnt lgkmcnt(6)
    v_mfma_f32_32x32x16_bf16 v[80:95], v[144:147], v[112:115], v[96:111]
    ds_read_b64_tr_b16 v[144:145], v200 offset:0
    ds_read_b64_tr_b16 v[146:147], v200 offset:2048
    v_exp_f32 v187, v75
    v_add_f32 v208, v208, v185
    v_cvt_pk_bf16_f32 v180, v184, v185
    v_mfma_f32_32x32x16_bf16 v[80:95], v[148:151], v[116:119], v[80:95]
    ds_read_b64_tr_b16 v[148:149], v201 offset:0
    ds_read_b64_tr_b16 v[150:151], v201 offset:2048
    v_exp_f32 v188, v76
    v_add_f32 v208, v208, v186
    s_waitcnt lgkmcnt(8)
    v_mfma_f32_32x32x16_bf16 v[80:95], v[152:155], v[120:123], v[80:95]
    ds_read_b64_tr_b16 v[152:153], v202 offset:0
    ds_read_b64_tr_b16 v[154:155], v202 offset:2048
    v_exp_f32 v189, v77
    v_add_f32 v208, v208, v187
    v_cvt_pk_bf16_f32 v181, v186, v187
    v_mfma_f32_32x32x16_bf16 v[80:95], v[156:159], v[124:127], v[80:95]
    ds_read_b64_tr_b16 v[156:157], v203 offset:0
    ds_read_b64_tr_b16 v[158:159], v203 offset:2048
    v_exp_f32 v190, v78
    v_add_f32 v208, v208, v188
    s_waitcnt lgkmcnt(10)
    v_mfma_f32_32x32x16_bf16 v[80:95], v[160:163], v[128:131], v[80:95]
    ds_read_b64_tr_b16 v[160:161], v200 offset:4096
    ds_read_b64_tr_b16 v[162:163], v200 offset:6144
    v_exp_f32 v191, v79
    v_add_f32 v208, v208, v189
    v_cvt_pk_bf16_f32 v182, v188, v189
    v_mfma_f32_32x32x16_bf16 v[80:95], v[164:167], v[132:135], v[80:95]
    ds_read_b64_tr_b16 v[164:165], v201 offset:4096
    ds_read_b64_tr_b16 v[166:167], v201 offset:6144
    v_add_f32 v208, v208, v190
    s_waitcnt lgkmcnt(12)
    v_mfma_f32_32x32x16_bf16 v[80:95], v[168:171], v[136:139], v[80:95]
    ds_read_b64_tr_b16 v[168:169], v202 offset:4096
    ds_read_b64_tr_b16 v[170:171], v202 offset:6144
    v_add_f32 v208, v208, v191
    v_cvt_pk_bf16_f32 v183, v190, v191
    v_mfma_f32_32x32x16_bf16 v[80:95], v[172:175], v[140:143], v[80:95]
    ds_read_b64_tr_b16 v[172:173], v203 offset:4096
    ds_read_b64_tr_b16 v[174:175], v203 offset:6144
    v_cmp_lt_f32 vcc, s42, v208
    s_cbranch_vccnz L_rare_13
L_back_14:
    v_add_f32 v207, v207, v208
    s_branch L_S_LOOP_X
L_S_LAST_X:
    s_waitcnt vmcnt(8) lgkmcnt(0)
    s_barrier
    v_mfma_f32_32x32x16_bf16 v[0:15], v[144:147], v[176:179], v[0:15]
    ds_read_b64_tr_b16 v[144:145], v200 offset:16384
    ds_read_b64_tr_b16 v[146:147], v200 offset:18432
    v_mfma_f32_32x32x16_bf16 v[16:31], v[148:151], v[176:179], v[16:31]
    ds_read_b64_tr_b16 v[148:149], v201 offset:16384
    ds_read_b64_tr_b16 v[150:151], v201 offset:18432
    s_nop 0
    v_exp_f32 v184, v80
    v_exp_f32 v185, v81
    v_mfma_f32_32x32x16_bf16 v[32:47], v[152:155], v[176:179], v[32:47]
    ds_read_b64_tr_b16 v[152:153], v202 offset:16384
    ds_read_b64_tr_b16 v[154:155], v202 offset:18432
    v_exp_f32 v186, v82
    v_exp_f32 v187, v83
    v_add_f32 v208, v184, v185
    v_mfma_f32_32x32x16_bf16 v[48:63], v[156:159], v[176:179], v[48:63]
    ds_read_b64_tr_b16 v[156:157], v203 offset:16384
    ds_read_b64_tr_b16 v[158:159], v203 offset:18432
    v_exp_f32 v188, v84
    v_exp_f32 v189, v85
    v_add_f32 v208, v208, v186
    v_cvt_pk_bf16_f32 v176, v184, v185
    v_mfma_f32_32x32x16_bf16 v[0:15], v[160:163], v[180:183], v[0:15]
    ds_read_b64_tr_b16 v[160:161], v200 offset:20480
    ds_read_b64_tr_b16 v[162:163], v200 offset:22528
    v_exp_f32 v190, v86
    v_exp_f32 v191, v87
    v_add_f32 v208, v208, v187
    v_cvt_pk_bf16_f32 v177, v186, v187
    v_mfma_f32_32x32x16_bf16 v[16:31], v[164:167], v[180:183], v[16:31]
    ds_read_b64_tr_b16 v[164:165], v201 offset:20480
    ds_read_b64_tr_b16 v[166:167], v201 offset:22528
    v_exp_f32 v184, v88
    v_add_f32 v208, v208, v188
    v_add_f32 v208, v208, v189
    v_cvt_pk_bf16_f32 v178, v188, v189
    v_mfma_f32_32x32x16_bf16 v[32:47], v[168:171], v[180:183], v[32:47]
    ds_read_b64_tr_b16 v[168:169], v202 offset:20480
    ds_read_b64_tr_b16 v[170:171], v202 offset:22528
    v_exp_f32 v185, v89
    v_add_f32 v208, v208, v190
    v_add_f32 v208, v208, v191
    v_cvt_pk_bf16_f32 v179, v190, v191
    v_mfma_f32_32x32x16_bf16 v[48:63], v[172:175], v[180:183], v[48:63]
    ds_read_b64_tr_b16 v[172:173], v203 offset:20480
    ds_read_b64_tr_b16 v[174:175], v203 offset:22528
    v_exp_f32 v186, v90
    v_add_f32 v208, v208, v184
    v_exp_f32 v187, v91
    v_add_f32 v208, v208, v185
    v_cvt_pk_bf16_f32 v180, v184, v185
    v_exp_f32 v188, v92
    v_add_f32 v208, v208, v186
    v_exp_f32 v189, v93
    v_add_f32 v208, v208, v187
    v_cvt_pk_bf16_f32 v181, v186, v187
    v_exp_f32 v190, v94
    v_add_f32 v208, v208, v188
    v_exp_f32 v191, v95
    v_add_f32 v208, v208, v189
    v_cvt_pk_bf16_f32 v182, v188, v189
    v_add_f32 v208, v208, v190
    v_add_f32 v208, v208, v191
    v_cvt_pk_bf16_f32 v183, v190, v191
    v_cmp_lt_f32 vcc, s42, v208
    s_cbranch_vccnz L_rare_15
L_back_16:
    v_add_f32 v207, v207, v208
    s_branch L_S_TAIL
L_S_PRE_Y:
L_S_FIRST_Y:
    s_waitcnt vmcnt(8) lgkmcnt(0)
    s_barrier
    ds_read_b128 v[144:147], v192 offset:16384
    ds_read_b128 v[148:151], v193 offset:16384
    ds_read_b128 v[152:155], v194 offset:16384
    ds_read_b128 v[156:159], v195 offset:16384
    ds_read_b128 v[160:163], v196 offset:16384
    ds_read_b128 v[164:167], v197 offset:16384
    ds_read_b128 v[168:171], v198 offset:16384
    ds_read_b128 v[172:175], v199 offset:16384
    s_mov_b32 m0, s62
    s_add_u32 s62, s62, 0x4000
    buffer_load_dwordx4 v204, s[12:15], s72 offen lds
    s_and_b32 s62, s62, 0xffff
    buffer_load_dwordx4 v205, s[12:15], s72 offen offset:1024 lds
    v_exp_f32 v184, v64
    v_exp_f32 v185, v65
    s_mov_b32 m0, s63
    s_add_u32 s63, s63, 0x4000
    buffer_load_dwordx4 v206, s[16:19], s73 offen lds
    v_exp_f32 v186, v66
    v_exp_f32 v187, v67
    v_add_f32 v208, v184, v185
    s_and_b32 s63, s63, 0xffff
    buffer_load_dwordx4 v206, s[16:19], s73 offen offset:1024 lds
    v_exp_f32 v188, v68
    v_exp_f32 v189, v69
    v_add_f32 v208, v208, v186
    v_cvt_pk_bf16_f32 v176, v184, v185
    s_or_b32 s63, s63, 0x10000
    s_add_u32 s32, s32, 1
    v_exp_f32 v190, v70
    v_exp_f32 v191, v71
    v_add_f32 v208, v208, v187
    v_cvt_pk_bf16_f32 v177, v186, v187
    s_add_u32 s33, s33, 1
    v_readlane_b32 s72, v225, s32
    v_exp_f32 v184, v72
    v_add_f32 v208, v208, v188
    v_add_f32 v208, v208, v189
    v_cvt_pk_bf16_f32 v178, v188, v189
    v_readlane_b32 s73, v225, s33
    v_exp_f32 v185, v73
    v_add_f32 v208, v208, v190
    v_add_f32 v208, v208, v191
    v_cvt_pk_bf16_f32 v179, v190, v191
    v_exp_f32 v186, v74
    v_add_f32 v208, v208, v184
    s_waitcnt lgkmcnt(6)
    v_mfma_f32_32x32x16_bf16 v[80:95], v[144:147], v[112:115], v[96:111]
    ds_read_b64_tr_b16 v[144:145], v200 offset:0
    ds_read_b64_tr_b16 v[146:147], v200 offset:2048
    v_exp_f32 v187, v75
    v_add_f32 v208, v208, v185
    v_cvt_pk_bf16_f32 v180, v184, v185
    v_mfma_f32_32x32x16_bf16 v[80:95], v[148:151], v[116:119], v[80:95]
    ds_read_b64_tr_b16 v[148:149], v201 offset:0
    ds_read_b64_tr_b16 v[150:151], v201 offset:2048
    v_exp_f32 v188, v76
    v_add_f32 v208, v208, v186
    s_waitcnt lgkmcnt(8)
    v_mfma_f32_32x32x16_bf16 v[80:95], v[152:155], v[120:123], v[80:95]
    ds_read_b64_tr_b16 v[152:153], v202 offset:0
    ds_read_b64_tr_b16 v[154:155], v202 offset:2048
    v_exp_f32 v189, v77
    v_add_f32 v208, v208, v187
    v_cvt_pk_bf16_f32 v181, v186, v187
    v_mfma_f32_32x32x16_bf16 v[80:95], v[156:159], v[124:127], v[80:95]
    ds_read_b64_tr_b16 v[156:157], v203 offset:0
    ds_read_b64_tr_b16 v[158:159], v203 offset:2048
    v_exp_f32 v190, v78
    v_add_f32 v208, v208, v188
    s_waitcnt lgkmcnt(10)
    v_mfma_f32_32x32x16_bf16 v[80:95], v[160:163], v[128:131], v[80:95]
    ds_read_b64_tr_b16 v[160:161], v200 offset:4096
    ds_read_b64_tr_b16 v[162:163], v200 offset:6144
    v_exp_f32 v191, v79
    v_add_f32 v208, v208, v189
    v_cvt_pk_bf16_f32 v182, v188, v189
    v_mfma_f32_32x32x16_bf16 v[80:95], v[164:167], v[132:135], v[80:95]
    ds_read_b64_tr_b16 v[164:165], v201 offset:4096
    ds_read_b64_tr_b16 v[166:167], v201 offset:6144
    v_add_f32 v208, v208, v190
    s_waitcnt lgkmcnt(12)
    v_mfma_f32_32x32x16_bf16 v[80:95], v[168:171], v[136:139], v[80:95]
    ds_read_b64_tr_b16 v[168:169], v202 offset:4096
    ds_read_b64_tr_b16 v[170:171], v202 offset:6144
    v_add_f32 v208, v208, v191
    v_cvt_pk_bf16_f32 v183, v190, v191
    v_mfma_f32_32x32x16_bf16 v[80:95], v[172:175], v[140:143], v[80:95]
    ds_read_b64_tr_b16 v[172:173], v203 offset:4096
    ds_read_b64_tr_b16 v[174:175], v203 offset:6144
    v_cmp_lt_f32 vcc, s42, v208
    s_cbranch_vccnz L_rare_17
L_back_18:
    v_add_f32 v207, v207, v208
L_S_LOOP_Y:
    s_cmp_gt_u32 s38, 1
    s_cbranch_scc1 L_S_GO_Y
    s_cmp_eq_u32 s38, s41
    s_cbranch_scc0 L_S_NOQB_Y
    s_lshl_b32 s53, s30, 8
    s_add_u32 s53, s53, s56
    s_add_u32 s54, s56, 131072
    s_mov_b32 m0, s54
    s_nop 0
    buffer_load_dwordx4 v204, s[8:11], s53 offen nt lds
    buffer_load_dwordx4 v205, s[8:11], s53 offen offset:1024 nt lds
    s_lshl_b32 s53, s30, 8
    s_add_u32 s53, s53, s56
    s_add_u32 s53, s53, 16384
    s_add_u32 s54, s56, 147456
    s_mov_b32 m0, s54
    s_nop 0
    buffer_load_dwordx4 v204, s[8:11], s53 offen nt lds
    buffer_load_dwordx4 v205, s[8:11], s53 offen offset:1024 nt lds
L_S_NOQB_Y:
    s_cmp_eq_u32 s38, 0
    s_cbranch_scc1 L_S_LAST_Y
L_S_GO_Y:
    s_sub_u32 s38, s38, 1
L_S_MID1_Y:
    s_waitcnt lgkmcnt(12)
    v_mfma_f32_32x32x16_bf16 v[0:15], v[144:147], v[176:179], v[0:15]
    v_mfma_f32_32x32x16_bf16 v[16:31], v[148:151], v[176:179], v[16:31]
    s_nop 5
    v_exp_f32 v184, v80
    v_exp_f32 v185, v81
    s_waitcnt lgkmcnt(8)
    v_mfma_f32_32x32x16_bf16 v[32:47], v[152:155], v[176:179], v[32:47]
    v_exp_f32 v186, v82
    v_exp_f32 v187, v83
    v_add_f32 v208, v184, v185
    v_mfma_f32_32x32x16_bf16 v[48:63], v[156:159], v[176:179], v[48:63]
    v_exp_f32 v188, v84
    v_exp_f32 v189, v85
    v_add_f32 v208, v208, v186
    v_cvt_pk_bf16_f32 v176, v184, v185
    s_waitcnt vmcnt(8) lgkmcnt(0)
    s_barrier
    v_mfma_f32_32x32x16_bf16 v[0:15], v[160:163], v[180:183], v[0:15]
    ds_read_b128 v[144:147], v192 offset:32768
    ds_read_b128 v[148:151], v193 offset:32768
    s_mov_b32 m0, s62
    s_add_u32 s62, s62, 0x4000
    buffer_load_dwordx4 v204, s[12:15], s72 offen lds
    v_exp_f32 v190, v86
    v_exp_f32 v191, v87
    v_add_f32 v208, v208, v187
    v_cvt_pk_bf16_f32 v177, v186, v187
    v_mfma_f32_32x32x16_bf16 v[16:31], v[164:167], v[180:183], v[16:31]
    ds_read_b128 v[152:155], v194 offset:32768
    ds_read_b128 v[156:159], v195 offset:32768
    s_and_b32 s62, s62, 0xffff
    buffer_load_dwordx4 v205, s[12:15], s72 offen offset:1024 lds
    v_exp_f32 v184, v88
    v_add_f32 v208, v208, v188
    v_add_f32 v208, v208, v189
    v_cvt_pk_bf16_f32 v178, v188, v189
    v_mfma_f32_32x32x16_bf16 v[32:47], v[168:171], v[180:183], v[32:47]
    ds_read_b128 v[160:163], v196 offset:32768
    ds_read_b128 v[164:167], v197 offset:32768
    s_mov_b32 m0, s63
    s_add_u32 s63, s63, 0x4000
    buffer_load_dwordx4 v206, s[16:19], s73 offen lds
    v_exp_f32 v185, v89
    v_add_f32 v208, v208, v190
    v_add_f32 v208, v208, v191
    v_cvt_pk_bf16_f32 v179, v190, v191
    v_mfma_f32_32x32x16_bf16 v[48:63], v[172:175], v[180:183], v[48:63]
    ds_read_b128 v[168:171], v198 offset:32768
    ds_read_b128 v[172:175], v199 offset:32768
    s_and_b32 s63, s63, 0xffff
    buffer_load_dwordx4 v206, s[16:19], s73 offen offset:1024 lds
    v_exp_f32 v186, v90
    v_add_f32 v208, v208, v184
    s_waitcnt lgkmcnt(6)
    v_mfma_f32_32x32x16_bf16 v[64:79], v[144:147], v[112:115], v[96:111]
    ds_read_b64_tr_b16 v[144:145], v200 offset:16384
    ds_read_b64_tr_b16 v[146:147], v200 offset:18432
    s_or_b32 s63, s63, 0x10000
    s_add_u32 s32, s32, 1
    v_exp_f32 v187, v91
    v_add_f32 v208, v208, v185
    v_cvt_pk_bf16_f32 v180, v184, v185
    v_mfma_f32_32x32x16_bf16 v[64:79], v[148:151], v[116:119], v[64:79]
    ds_read_b64_tr_b16 v[148:149], v201 offset:16384
    ds_read_b64_tr_b16 v[150:151], v201 offset:18432
    s_add_u32 s33, s33, 1
    v_readlane_b32 s72, v225, s32
    v_exp_f32 v188, v92
    v_add_f32 v208, v208, v186
    s_waitcnt lgkmcnt(8)
    v_mfma_f32_32x32x16_bf16 v[64:79], v[152:155], v[120:123], v[64:79]
    ds_read_b64_tr_b16 v[152:153], v202 offset:16384
    ds_read_b64_tr_b16 v[154:155], v202 offset:18432
    v_readlane_b32 s73, v225, s33
    v_exp_f32 v189, v93
    v_add_f32 v208, v208, v187
    v_cvt_pk_bf16_f32 v181, v186, v187
    v_mfma_f32_32x32x16_bf16 v[64:79], v[156:159], v[124:127], v[64:79]
    ds_read_b64_tr_b16 v[156:157], v203 offset:16384
    ds_read_b64_tr_b16 v[158:159], v203 offset:18432
    v_exp_f32 v190, v94
    v_add_f32 v208, v208, v188
    s_waitcnt lgkmcnt(10)
    v_mfma_f32_32x32x16_bf16 v[64:79], v[160:163], v[128:131], v[64:79]
    ds_read_b64_tr_b16 v[160:161], v200 offset:20480
    ds_read_b64_tr_b16 v[162:163], v200 offset:22528
    v_exp_f32 v191, v95
    v_add_f32 v208, v208, v189
    v_cvt_pk_bf16_f32 v182, v188, v189
    v_mfma_f32_32x32x16_bf16 v[64:79], v[164:167], v[132:135], v[64:79]
    ds_read_b64_tr_b16 v[164:165], v201 offset:20480
    ds_read_b64_tr_b16 v[166:167], v201 offset:22528
    v_add_f32 v208, v208, v190
    s_waitcnt lgkmcnt(12)
    v_mfma_f32_32x32x16_bf16 v[64:79], v[168:171], v[136:139], v[64:79]
    ds_read_b64_tr_b16 v[168:169], v202 offset:20480
    ds_read_b64_tr_b16 v[170:171], v202 offset:22528
    v_add_f32 v208, v208, v191
    v_cvt_pk_bf16_f32 v183, v190, v191
    v_mfma_f32_32x32x16_bf16 v[64:79], v[172:175], v[140:143], v[64:79]
    ds_read_b64_tr_b16 v[172:173], v203 offset:20480
    ds_read_b64_tr_b16 v[174:175], v203 offset:22528
    v_cmp_lt_f32 vcc, s42, v208
    s_cbranch_vccnz L_rare_19
L_back_20:
    v_add_f32 v207, v207, v208
L_S_MID2_Y:
    s_waitcnt lgkmcnt(12)
    v_mfma_f32_32x32x16_bf16 v[0:15], v[144:147], v[176:179], v[0:15]
    v_mfma_f32_32x32x16_bf16 v[16:31], v[148:151], v[176:179], v[16:31]
    s_nop 5
    v_exp_f32 v184, v64
    v_exp_f32 v185, v65
    s_waitcnt lgkmcnt(8)
    v_mfma_f32_32x32x16_bf16 v[32:47], v[152:155], v[176:179], v[32:47]
    v_exp_f32 v186, v66
    v_exp_f32 v187, v67
    v_add_f32 v208, v184, v185
    v_mfma_f32_32x32x16_bf16 v[48:63], v[156:159], v[176:179], v[48:63]
    v_exp_f32 v188, v68
    v_exp_f32 v189, v69
    v_add_f32 v208, v208, v186
    v_cvt_pk_bf16_f32 v176, v184, v185
    s_waitcnt vmcnt(8) lgkmcnt(0)
    s_barrier
    v_mfma_f32_32x32x16_bf16 v[0:15], v[160:163], v[180:183], v[0:15]
    ds_read_b128 v[144:147], v192 offset:49152
    ds_read_b128 v[148:151], v193 offset:49152
    s_mov_b32 m0, s62
    s_add_u32 s62, s62, 0x4000
    buffer_load_dwordx4 v204, s[12:15], s72 offen lds
    v_exp_f32 v190, v70
    v_exp_f32 v191, v71
    v_add_f32 v208, v208, v187
    v_cvt_pk_bf16_f32 v177, v186, v187
    v_mfma_f32_32x32x16_bf16 v[16:31], v[164:167], v[180:183], v[16:31]
    ds_read_b128 v[152:155], v194 offset:49152
    ds_read_b128 v[156:159], v195 offset:49152
    s_and_b32 s62, s62, 0xffff
    buffer_load_dwordx4 v205, s[12:15], s72 offen offset:1024 lds
    v_exp_f32 v184, v72
    v_add_f32 v208, v208, v188
    v_add_f32 v208, v208, v189
    v_cvt_pk_bf16_f32 v178, v188, v189
    v_mfma_f32_32x32x16_bf16 v[32:47], v[168:171], v[180:183], v[32:47]
    ds_read_b128 v[160:163], v196 offset:49152
    ds_read_b128 v[164:167], v197 offset:49152
    s_mov_b32 m0, s63
    s_add_u32 s63, s63, 0x4000
    buffer_load_dwordx4 v206, s[16:19], s73 offen lds
    v_exp_f32 v185, v73
    v_add_f32 v208, v208, v190
    v_add_f32 v208, v208, v191
    v_cvt_pk_bf16_f32 v179, v190, v191
    v_mfma_f32_32x32x16_bf16 v[48:63], v[172:175], v[180:183], v[48:63]
    ds_read_b128 v[168:171], v198 offset:49152
    ds_read_b128 v[172:175], v199 offset:49152
    s_and_b32 s63, s63, 0xffff
    buffer_load_dwordx4 v206, s[16:19], s73 offen offset:1024 lds
    v_exp_f32 v186, v74
    v_add_f32 v208, v208, v184
    s_waitcnt lgkmcnt(6)
    v_mfma_f32_32x32x16_bf16 v[80:95], v[144:147], v[112:115], v[96:111]
    ds_read_b64_tr_b16 v[144:145], v200 offset:32768
    ds_read_b64_tr_b16 v[146:147], v200 offset:34816
    s_or_b32 s63, s63, 0x10000
    s_add_u32 s32, s32, 1
    v_exp_f32 v187, v75
    v_add_f32 v208, v208, v185
    v_cvt_pk_bf16_f32 v180, v184, v185
    v_mfma_f32_32x32x16_bf16 v[80:95], v[148:151], v[116:119], v[80:95]
    ds_read_b64_tr_b16 v[148:149], v201 offset:32768
    ds_read_b64_tr_b16 v[150:151], v201 offset:34816
    s_add_u32 s33, s33, 1
    v_readlane_b32 s72, v225, s32
    v_exp_f32 v188, v76
    v_add_f32 v208, v208, v186
    s_waitcnt lgkmcnt(8)
    v_mfma_f32_32x32x16_bf16 v[80:95], v[152:155], v[120:123], v[80:95]
    ds_read_b64_tr_b16 v[152:153], v202 offset:32768
    ds_read_b64_tr_b16 v[154:155], v202 offset:34816
    v_readlane_b32 s73, v225, s33
    v_exp_f32 v189, v77
    v_add_f32 v208, v208, v187
    v_cvt_pk_bf16_f32 v181, v186, v187
    v_mfma_f32_32x32x16_bf16 v[80:95], v[156:159], v[124:127], v[80:95]
    ds_read_b64_tr_b16 v[156:157], v203 offset:32768
    ds_read_b64_tr_b16 v[158:159], v203 offset:34816
    v_exp_f32 v190, v78
    v_add_f32 v208, v208, v188
    s_waitcnt lgkmcnt(10)
    v_mfma_f32_32x32x16_bf16 v[80:95], v[160:163], v[128:131], v[80:95]
    ds_read_b64_tr_b16 v[160:161], v200 offset:36864
    ds_read_b64_tr_b16 v[162:163], v200 offset:38912
    v_exp_f32 v191, v79
    v_add_f32 v208, v208, v189
    v_cvt_pk_bf16_f32 v182, v188, v189
    v_mfma_f32_32x32x16_bf16 v[80:95], v[164:167], v[132:135], v[80:95]
    ds_read_b64_tr_b16 v[164:165], v201 offset:36864
    ds_read_b64_tr_b16 v[166:167], v201 offset:38912
    v_add_f32 v208, v208, v190
    s_waitcnt lgkmcnt(12)
    v_mfma_f32_32x32x16_bf16 v[80:95], v[168:171], v[136:139], v[80:95]
    ds_read_b64_tr_b16 v[168:169], v202 offset:36864
    ds_read_b64_tr_b16 v[170:171], v202 offset:38912
    v_add_f32 v208, v208, v191
    v_cvt_pk_bf16_f32 v183, v190, v191
    v_mfma_f32_32x32x16_bf16 v[80:95], v[172:175], v[140:143], v[80:95]
    ds_read_b64_tr_b16 v[172:173], v203 offset:36864
    ds_read_b64_tr_b16 v[174:175], v203 offset:38912
    v_cmp_lt_f32 vcc, s42, v208
    s_cbranch_vccnz L_rare_21
L_back_22:
    v_add_f32 v207, v207, v208
L_S_MID3_Y:
    s_waitcnt lgkmcnt(12)
    v_mfma_f32_32x32x16_bf16 v[0:15], v[144:147], v[176:179], v[0:15]
    v_mfma_f32_32x32x16_bf16 v[16:31], v[148:151], v[176:179], v[16:31]
    s_nop 5
    v_exp_f32 v184, v80
    v_exp_f32 v185, v81
    s_waitcnt lgkmcnt(8)
    v_mfma_f32_32x32x16_bf16 v[32:47], v[152:155], v[176:179], v[32:47]
    v_exp_f32 v186, v82
    v_exp_f32 v187, v83
    v_add_f32 v208, v184, v185
    v_mfma_f32_32x32x16_bf16 v[48:63], v[156:159], v[176:179], v[48:63]
    v_exp_f32 v188, v84
    v_exp_f32 v189, v85
    v_add_f32 v208, v208, v186
    v_cvt_pk_bf16_f32 v176, v184, v185
    s_waitcnt vmcnt(8) lgkmcnt(0)
    s_barrier
    v_mfma_f32_32x32x16_bf16 v[0:15], v[160:163], v[180:183], v[0:15]
    ds_read_b128 v[144:147], v192 offset:0
    ds_read_b128 v[148:151], v193 offset:0
    s_mov_b32 m0, s62
    s_add_u32 s62, s62, 0x4000
    buffer_load_dwordx4 v204, s[12:15], s72 offen lds
    v_exp_f32 v190, v86
    v_exp_f32 v191, v87
    v_add_f32 v208, v208, v187
    v_cvt_pk_bf16_f32 v177, v186, v187
    v_mfma_f32_32x32x16_bf16 v[16:31], v[164:167], v[180:183], v[16:31]
    ds_read_b128 v[152:155], v194 offset:0
    ds_read_b128 v[156:159], v195 offset:0
    s_and_b32 s62, s62, 0xffff
    buffer_load_dwordx4 v205, s[12:15], s72 offen offset:1024 lds
    v_exp_f32 v184, v88
    v_add_f32 v208, v208, v188
    v_add_f32 v208, v208, v189
    v_cvt_pk_bf16_f32 v178, v188, v189
    v_mfma_f32_32x32x16_bf16 v[32:47], v[168:171], v[180:183], v[32:47]
    ds_read_b128 v[160:163], v196 offset:0
    ds_read_b128 v[164:167], v197 offset:0
    s_mov_b32 m0, s63
    s_add_u32 s63, s63, 0x4000
    buffer_load_dwordx4 v206, s[16:19], s73 offen lds
    v_exp_f32 v185, v89
    v_add_f32 v208, v208, v190
    v_add_f32 v208, v208, v191
    v_cvt_pk_bf16_f32 v179, v190, v191
    v_mfma_f32_32x32x16_bf16 v[48:63], v[172:175], v[180:183], v[48:63]
    ds_read_b128 v[168:171], v198 offset:0
    ds_read_b128 v[172:175], v199 offset:0
    s_and_b32 s63, s63, 0xffff
    buffer_load_dwordx4 v206, s[16:19], s73 offen offset:1024 lds
    v_exp_f32 v186, v90
    v_add_f32 v208, v208, v184
    s_waitcnt lgkmcnt(6)
    v_mfma_f32_32x32x16_bf16 v[64:79], v[144:147], v[112:115], v[96:111]
    ds_read_b64_tr_b16 v[144:145], v200 offset:49152
    ds_read_b64_tr_b16 v[146:147], v200 offset:51200
    s_or_b32 s63, s63, 0x10000
    s_add_u32 s32, s32, 1
    v_exp_f32 v187, v91
    v_add_f32 v208, v208, v185
    v_cvt_pk_bf16_f32 v180, v184, v185
    v_mfma_f32_32x32x16_bf16 v[64:79], v[148:151], v[116:119], v[64:79]
    ds_read_b64_tr_b16 v[148:149], v201 offset:49152
    ds_read_b64_tr_b16 v[150:151], v201 offset:51200
    s_add_u32 s33, s33, 1
    v_readlane_b32 s72, v225, s32
    v_exp_f32 v188, v92
    v_add_f32 v208, v208, v186
    s_waitcnt lgkmcnt(8)
    v_mfma_f32_32x32x16_bf16 v[64:79], v[152:155], v[120:123], v[64:79]
    ds_read_b64_tr_b16 v[152:153], v202 offset:49152
    ds_read_b64_tr_b16 v[154:155], v202 offset:51200
    v_readlane_b32 s73, v225, s33
    v_exp_f32 v189, v93
    v_add_f32 v208, v208, v187
    v_cvt_pk_bf16_f32 v181, v186, v187
    v_mfma_f32_32x32x16_bf16 v[64:79], v[156:159], v[124:127], v[64:79]
    ds_read_b64_tr_b16 v[156:157], v203 offset:49152
    ds_read_b64_tr_b16 v[158:159], v203 offset:51200
    v_exp_f32 v190, v94
    v_add_f32 v208, v208, v188
    s_waitcnt lgkmcnt(10)
    v_mfma_f32_32x32x16_bf16 v[64:79], v[160:163], v[128:131], v[64:79]
    ds_read_b64_tr_b16 v[160:161], v200 offset:53248
    ds_read_b64_tr_b16 v[162:163], v200 offset:55296
    v_exp_f32 v191, v95
    v_add_f32 v208, v208, v189
    v_cvt_pk_bf16_f32 v182, v188, v189
    v_mfma_f32_32x32x16_bf16 v[64:79], v[164:167], v[132:135], v[64:79]
    ds_read_b64_tr_b16 v[164:165], v201 offset:53248
    ds_read_b64_tr_b16 v[166:167], v201 offset:55296
    v_add_f32 v208, v208, v190
    s_waitcnt lgkmcnt(12)
    v_mfma_f32_32x32x16_bf16 v[64:79], v[168:171], v[136:139], v[64:79]
    ds_read_b64_tr_b16 v[168:169], v202 offset:53248
    ds_read_b64_tr_b16 v[170:171], v202 offset:55296
    v_add_f32 v208, v208, v191
    v_cvt_pk_bf16_f32 v183, v190, v191
    v_mfma_f32_32x32x16_bf16 v[64:79], v[172:175], v[140:143], v[64:79]
    ds_read_b64_tr_b16 v[172:173], v203 offset:53248
    ds_read_b64_tr_b16 v[174:175], v203 offset:55296
    v_cmp_lt_f32 vcc, s42, v208
    s_cbranch_vccnz L_rare_23
L_back_24:
    v_add_f32 v207, v207, v208
L_S_MID0_Y:
    s_waitcnt lgkmcnt(12)
    v_mfma_f32_32x32x16_bf16 v[0:15], v[144:147], v[176:179], v[0:15]
    v_mfma_f32_32x32x16_bf16 v[16:31], v[148:151], v[176:179], v[16:31]
    s_nop 5
    v_exp_f32 v184, v64
    v_exp_f32 v185, v65
    s_waitcnt lgkmcnt(8)
    v_mfma_f32_32x32x16_bf16 v[32:47], v[152:155], v[176:179], v[32:47]
    v_exp_f32 v186, v66
    v_exp_f32 v187, v67
    v_add_f32 v208, v184, v185
    v_mfma_f32_32x32x16_bf16 v[48:63], v[156:159], v[176:179], v[48:63]
    v_exp_f32 v188, v68
    v_exp_f32 v189, v69
    v_add_f32 v208, v208, v186
    v_cvt_pk_bf16_f32 v176, v184, v185
    s_waitcnt vmcnt(8) lgkmcnt(0)
    s_barrier
    v_mfma_f32_32x32x16_bf16 v[0:15], v[160:163], v[180:183], v[0:15]
    ds_read_b128 v[144:147], v192 offset:16384
    ds_read_b128 v[148:151], v193 offset:16384
    s_mov_b32 m0, s62
    s_add_u32 s62, s62, 0x4000
    buffer_load_dwordx4 v204, s[12:15], s72 offen lds
    v_exp_f32 v190, v70
    v_exp_f32 v191, v71
    v_add_f32 v208, v208, v187
    v_cvt_pk_bf16_f32 v177, v186, v187
    v_mfma_f32_32x32x16_bf16 v[16:31], v[164:167], v[180:183], v[16:31]
    ds_read_b128 v[152:155], v194 offset:16384
    ds_read_b128 v[156:159], v195 offset:16384
    s_and_b32 s62, s62, 0xffff
    buffer_load_dwordx4 v205, s[12:15], s72 offen offset:1024 lds
    v_exp_f32 v184, v72
    v_add_f32 v208, v208, v188
    v_add_f32 v208, v208, v189
    v_cvt_pk_bf16_f32 v178, v188, v189
    v_mfma_f32_32x32x16_bf16 v[32:47], v[168:171], v[180:183], v[32:47]
    ds_read_b128 v[160:163], v196 offset:16384
    ds_read_b128 v[164:167], v197 offset:16384
    s_mov_b32 m0, s63
    s_add_u32 s63, s63, 0x4000
    buffer_load_dwordx4 v206, s[16:19], s73 offen lds
    v_exp_f32 v185, v73
    v_add_f32 v208, v208, v190
    v_add_f32 v208, v208, v191
    v_cvt_pk_bf16_f32 v179, v190, v191
    v_mfma_f32_32x32x16_bf16 v[48:63], v[172:175], v[180:183], v[48:63]
    ds_read_b128 v[168:171], v198 offset:16384
    ds_read_b128 v[172:175], v199 offset:16384
    s_and_b32 s63, s63, 0xffff
    buffer_load_dwordx4 v206, s[16:19], s73 offen offset:1024 lds
    v_exp_f32 v186, v74
    v_add_f32 v208, v208, v184
    s_waitcnt lgkmcnt(6)
    v_mfma_f32_32x32x16_bf16 v[80:95], v[144:147], v[112:115], v[96:111]
    ds_read_b64_tr_b16 v[144:145], v200 offset:0
    ds_read_b64_tr_b16 v[146:147], v200 offset:2048
    s_or_b32 s63, s63, 0x10000
    s_add_u32 s32, s32, 1
    v_exp_f32 v187, v75
    v_add_f32 v208, v208, v185
    v_cvt_pk_bf16_f32 v180, v184, v185
    v_mfma_f32_32x32x16_bf16 v[80:95], v[148:151], v[116:119], v[80:95]
    ds_read_b64_tr_b16 v[148:149], v201 offset:0
    ds_read_b64_tr_b16 v[150:151], v201 offset:2048
    s_add_u32 s33, s33, 1
    v_readlane_b32 s72, v225, s32
    v_exp_f32 v188, v76
    v_add_f32 v208, v208, v186
    s_waitcnt lgkmcnt(8)
    v_mfma_f32_32x32x16_bf16 v[80:95], v[152:155], v[120:123], v[80:95]
    ds_read_b64_tr_b16 v[152:153], v202 offset:0
    ds_read_b64_tr_b16 v[154:155], v202 offset:2048
    v_readlane_b32 s73, v225, s33
    v_exp_f32 v189, v77
    v_add_f32 v208, v208, v187
    v_cvt_pk_bf16_f32 v181, v186, v187
    v_mfma_f32_32x32x16_bf16 v[80:95], v[156:159], v[124:127], v[80:95]
    ds_read_b64_tr_b16 v[156:157], v203 offset:0
    ds_read_b64_tr_b16 v[158:159], v203 offset:2048
    v_exp_f32 v190, v78
    v_add_f32 v208, v208, v188
    s_waitcnt lgkmcnt(10)
    v_mfma_f32_32x32x16_bf16 v[80:95], v[160:163], v[128:131], v[80:95]
    ds_read_b64_tr_b16 v[160:161], v200 offset:4096
    ds_read_b64_tr_b16 v[162:163], v200 offset:6144
    v_exp_f32 v191, v79
    v_add_f32 v208, v208, v189
    v_cvt_pk_bf16_f32 v182, v188, v189
    v_mfma_f32_32x32x16_bf16 v[80:95], v[164:167], v[132:135], v[80:95]
    ds_read_b64_tr_b16 v[164:165], v201 offset:4096
    ds_read_b64_tr_b16 v[166:167], v201 offset:6144
    v_add_f32 v208, v208, v190
    s_waitcnt lgkmcnt(12)
    v_mfma_f32_32x32x16_bf16 v[80:95], v[168:171], v[136:139], v[80:95]
    ds_read_b64_tr_b16 v[168:169], v202 offset:4096
    ds_read_b64_tr_b16 v[170:171], v202 offset:6144
    v_add_f32 v208, v208, v191
    v_cvt_pk_bf16_f32 v183, v190, v191
    v_mfma_f32_32x32x16_bf16 v[80:95], v[172:175], v[140:143], v[80:95]
    ds_read_b64_tr_b16 v[172:173], v203 offset:4096
    ds_read_b64_tr_b16 v[174:175], v203 offset:6144
    v_cmp_lt_f32 vcc, s42, v208
    s_cbranch_vccnz L_rare_25
L_back_26:
    v_add_f32 v207, v207, v208
    s_branch L_S_LOOP_Y
L_S_LAST_Y:
    s_waitcnt lgkmcnt(12)
    v_mfma_f32_32x32x16_bf16 v[0:15], v[144:147], v[176:179], v[0:15]
    v_mfma_f32_32x32x16_bf16 v[16:31], v[148:151], v[176:179], v[16:31]
    s_nop 5
    v_exp_f32 v184, v80
    v_exp_f32 v185, v81
    s_waitcnt lgkmcnt(8)
    v_mfma_f32_32x32x16_bf16 v[32:47], v[152:155], v[176:179], v[32:47]
    v_exp_f32 v186, v82
    v_exp_f32 v187, v83
    v_add_f32 v208, v184, v185
    v_mfma_f32_32x32x16_bf16 v[48:63], v[156:159], v[176:179], v[48:63]
    v_exp_f32 v188, v84
    v_exp_f32 v189, v85
    v_add_f32 v208, v208, v186
    v_cvt_pk_bf16_f32 v176, v184, v185
    s_waitcnt vmcnt(8) lgkmcnt(0)
    s_barrier
    v_mfma_f32_32x32x16_bf16 v[0:15], v[160:163], v[180:183], v[0:15]
    ds_read_b64_tr_b16 v[144:145], v200 offset:16384
    ds_read_b64_tr_b16 v[146:147], v200 offset:18432
    ds_read_b64_tr_b16 v[148:149], v201 offset:16384
    ds_read_b64_tr_b16 v[150:151], v201 offset:18432
    v_exp_f32 v190, v86
    v_exp_f32 v191, v87
    v_add_f32 v208, v208, v187
    v_cvt_pk_bf16_f32 v177, v186, v187
    v_mfma_f32_32x32x16_bf16 v[16:31], v[164:167], v[180:183], v[16:31]
    ds_read_b64_tr_b16 v[152:153], v202 offset:16384
    ds_read_b64_tr_b16 v[154:155], v202 offset:18432
    ds_read_b64_tr_b16 v[156:157], v203 offset:16384
    ds_read_b64_tr_b16 v[158:159], v203 offset:18432
    v_exp_f32 v184, v88
    v_add_f32 v208, v208, v188
    v_add_f32 v208, v208, v189
    v_cvt_pk_bf16_f32 v178, v188, v189
    v_mfma_f32_32x32x16_bf16 v[32:47], v[168:171], v[180:183], v[32:47]
    ds_read_b64_tr_b16 v[160:161], v200 offset:20480
    ds_read_b64_tr_b16 v[162:163], v200 offset:22528
    ds_read_b64_tr_b16 v[164:165], v201 offset:20480
    ds_read_b64_tr_b16 v[166:167], v201 offset:22528
    v_exp_f32 v185, v89
    v_add_f32 v208, v208, v190
    v_add_f32 v208, v208, v191
    v_cvt_pk_bf16_f32 v179, v190, v191
    v_mfma_f32_32x32x16_bf16 v[48:63], v[172:175], v[180:183], v[48:63]
    ds_read_b64_tr_b16 v[168:169], v202 offset:20480
    ds_read_b64_tr_b16 v[170:171], v202 offset:22528
    ds_read_b64_tr_b16 v[172:173], v203 offset:20480
    ds_read_b64_tr_b16 v[174:175], v203 offset:22528
    v_exp_f32 v186, v90
    v_add_f32 v208, v208, v184
    v_exp_f32 v187, v91
    v_add_f32 v208, v208, v185
    v_cvt_pk_bf16_f32 v180, v184, v185
    v_exp_f32 v188, v92
    v_add_f32 v208, v208, v186
    v_exp_f32 v189, v93
    v_add_f32 v208, v208, v187
    v_cvt_pk_bf16_f32 v181, v186, v187
    v_exp_f32 v190, v94
    v_add_f32 v208, v208, v188
    v_exp_f32 v191, v95
    v_add_f32 v208, v208, v189
    v_cvt_pk_bf16_f32 v182, v188, v189
    v_add_f32 v208, v208, v190
    v_add_f32 v208, v208, v191
    v_cvt_pk_bf16_f32 v183, v190, v191
    v_cmp_lt_f32 vcc, s42, v208
    s_cbranch_vccnz L_rare_27
L_back_28:
    v_add_f32 v207, v207, v208
L_S_TAIL:
    s_waitcnt lgkmcnt(12)
    s_nop 0
    v_mfma_f32_32x32x16_bf16 v[0:15], v[144:147], v[176:179], v[0:15]
    v_mfma_f32_32x32x16_bf16 v[16:31], v[148:151], v[176:179], v[16:31]
    s_waitcnt lgkmcnt(8)
    v_mfma_f32_32x32x16_bf16 v[32:47], v[152:155], v[176:179], v[32:47]
    v_mfma_f32_32x32x16_bf16 v[48:63], v[156:159], v[176:179], v[48:63]
    s_waitcnt lgkmcnt(4)
    v_mfma_f32_32x32x16_bf16 v[0:15], v[160:163], v[180:183], v[0:15]
    v_mfma_f32_32x32x16_bf16 v[16:31], v[164:167], v[180:183], v[16:31]
    s_waitcnt lgkmcnt(0)
    v_mfma_f32_32x32x16_bf16 v[32:47], v[168:171], v[180:183], v[32:47]
    v_mfma_f32_32x32x16_bf16 v[48:63], v[172:175], v[180:183], v[48:63]
    s_nop 15
    s_nop 3
    s_waitcnt vmcnt(0)
    s_barrier
    s_lshl_b32 s53, s26, 13
    s_add_u32 s54, s53, 65536
    v_add_u32 v211, s54, v226
    s_add_u32 s54, s53, 131072
    v_add_u32 v212, s54, v226
    s_lshl_b32 s54, s26, 10
    s_add_u32 s54, s54, 16384
    v_add_u32 v213, s54, v226
    s_cmp_eq_u32 s25, 0
    s_cbranch_scc1 L_MRG_X
    s_add_u32 s54, s53, 131072
    s_sub_u32 s54, s54, s35
    v_add_u32 v64, s54, v192
    v_add_u32 v65, s54, v193
    v_add_u32 v66, s54, v194
    v_add_u32 v67, s54, v195
    v_add_u32 v68, s54, v196
    v_add_u32 v69, s54, v197
    v_add_u32 v70, s54, v198
    v_add_u32 v71, s54, v199
    ds_read_b128 v[112:115], v64
    ds_read_b128 v[116:119], v65
    ds_read_b128 v[120:123], v66
    ds_read_b128 v[124:127], v67
    ds_read_b128 v[128:131], v68
    ds_read_b128 v[132:135], v69
    ds_read_b128 v[136:139], v70
    ds_read_b128 v[140:143], v71
    v_mov_b32 v80, v96
    v_mov_b32 v81, v207
    ds_write_b64 v213, v[80:81]
    ds_write_b128 v211, v[0:3] offset:0
    ds_write_b128 v211, v[4:7] offset:1024
    ds_write_b128 v211, v[8:11] offset:2048
    ds_write_b128 v211, v[12:15] offset:3072
    ds_write_b128 v211, v[16:19] offset:4096
    ds_write_b128 v211, v[20:23] offset:5120
    ds_write_b128 v211, v[24:27] offset:6144
    ds_write_b128 v211, v[28:31] offset:7168
    s_waitcnt lgkmcnt(9)
    ds_write_b128 v212, v[32:35] offset:0
    ds_write_b128 v212, v[36:39] offset:1024
    ds_write_b128 v212, v[40:43] offset:2048
    ds_write_b128 v212, v[44:47] offset:3072
    ds_write_b128 v212, v[48:51] offset:4096
    ds_write_b128 v212, v[52:55] offset:5120
    ds_write_b128 v212, v[56:59] offset:6144
    ds_write_b128 v212, v[60:63] offset:7168
    s_waitcnt lgkmcnt(0)
    s_barrier
    s_mov_b32 s53, 0x3e0293ee
    v_lshlrev_b32 v211, 16, v112
    v_and_b32 v212, 0xffff0000, v112
    v_mul_f32 v211, s53, v211
    v_mul_f32 v212, s53, v212
    v_cvt_pk_bf16_f32 v112, v211, v212
    v_lshlrev_b32 v213, 16, v113
    v_and_b32 v214, 0xffff0000, v113
    v_mul_f32 v213, s53, v213
    v_mul_f32 v214, s53, v214
    v_cvt_pk_bf16_f32 v113, v213, v214
    v_lshlrev_b32 v215, 16, v114
    v_and_b32 v216, 0xffff0000, v114
    v_mul_f32 v215, s53, v215
    v_mul_f32 v216, s53, v216
    v_cvt_pk_bf16_f32 v114, v215, v216
    v_lshlrev_b32 v217, 16, v115
    v_and_b32 v218, 0xffff0000, v115
    v_mul_f32 v217, s53, v217
    v_mul_f32 v218, s53, v218
    v_cvt_pk_bf16_f32 v115, v217, v218
    v_lshlrev_b32 v211, 16, v116
    v_and_b32 v212, 0xffff0000, v116
    v_mul_f32 v211, s53, v211
    v_mul_f32 v212, s53, v212
    v_cvt_pk_bf16_f32 v116, v211, v212
    v_lshlrev_b32 v213, 16, v117
    v_and_b32 v214, 0xffff0000, v117
    v_mul_f32 v213, s53, v213
    v_mul_f32 v214, s53, v214
    v_cvt_pk_bf16_f32 v117, v213, v214
    v_lshlrev_b32 v215, 16, v118
    v_and_b32 v216, 0xffff0000, v118
    v_mul_f32 v215, s53, v215
    v_mul_f32 v216, s53, v216
    v_cvt_pk_bf16_f32 v118, v215, v216
    v_lshlrev_b32 v217, 16, v119
    v_and_b32 v218, 0xffff0000, v119
    v_mul_f32 v217, s53, v217
    v_mul_f32 v218, s53, v218
    v_cvt_pk_bf16_f32 v119, v217, v218
    v_lshlrev_b32 v211, 16, v120
    v_and_b32 v212, 0xffff0000, v120
    v_mul_f32 v211, s53, v211
    v_mul_f32 v212, s53, v212
    v_cvt_pk_bf16_f32 v120, v211, v212
    v_lshlrev_b32 v213, 16, v121
    v_and_b32 v214, 0xffff0000, v121
    v_mul_f32 v213, s53, v213
    v_mul_f32 v214, s53, v214
    v_cvt_pk_bf16_f32 v121, v213, v214
    v_lshlrev_b32 v215, 16, v122
    v_and_b32 v216, 0xffff0000, v122
    v_mul_f32 v215, s53, v215
    v_mul_f32 v216, s53, v216
    v_cvt_pk_bf16_f32 v122, v215, v216
    v_lshlrev_b32 v217, 16, v123
    v_and_b32 v218, 0xffff0000, v123
    v_mul_f32 v217, s53, v217
    v_mul_f32 v218, s53, v218
    v_cvt_pk_bf16_f32 v123, v217, v218
    v_lshlrev_b32 v211, 16, v124
    v_and_b32 v212, 0xffff0000, v124
    v_mul_f32 v211, s53, v211
    v_mul_f32 v212, s53, v212
    v_cvt_pk_bf16_f32 v124, v211, v212
    v_lshlrev_b32 v213, 16, v125
    v_and_b32 v214, 0xffff0000, v125
    v_mul_f32 v213, s53, v213
    v_mul_f32 v214, s53, v214
    v_cvt_pk_bf16_f32 v125, v213, v214
    v_lshlrev_b32 v215, 16, v126
    v_and_b32 v216, 0xffff0000, v126
    v_mul_f32 v215, s53, v215
    v_mul_f32 v216, s53, v216
    v_cvt_pk_bf16_f32 v126, v215, v216
    v_lshlrev_b32 v217, 16, v127
    v_and_b32 v218, 0xffff0000, v127
    v_mul_f32 v217, s53, v217
    v_mul_f32 v218, s53, v218
    v_cvt_pk_bf16_f32 v127, v217, v218
    v_lshlrev_b32 v211, 16, v128
    v_and_b32 v212, 0xffff0000, v128
    v_mul_f32 v211, s53, v211
    v_mul_f32 v212, s53, v212
    v_cvt_pk_bf16_f32 v128, v211, v212
    v_lshlrev_b32 v213, 16, v129
    v_and_b32 v214, 0xffff0000, v129
    v_mul_f32 v213, s53, v213
    v_mul_f32 v214, s53, v214
    v_cvt_pk_bf16_f32 v129, v213, v214
    v_lshlrev_b32 v215, 16, v130
    v_and_b32 v216, 0xffff0000, v130
    v_mul_f32 v215, s53, v215
    v_mul_f32 v216, s53, v216
    v_cvt_pk_bf16_f32 v130, v215, v216
    v_lshlrev_b32 v217, 16, v131
    v_and_b32 v218, 0xffff0000, v131
    v_mul_f32 v217, s53, v217
    v_mul_f32 v218, s53, v218
    v_cvt_pk_bf16_f32 v131, v217, v218
    v_lshlrev_b32 v211, 16, v132
    v_and_b32 v212, 0xffff0000, v132
    v_mul_f32 v211, s53, v211
    v_mul_f32 v212, s53, v212
    v_cvt_pk_bf16_f32 v132, v211, v212
    v_lshlrev_b32 v213, 16, v133
    v_and_b32 v214, 0xffff0000, v133
    v_mul_f32 v213, s53, v213
    v_mul_f32 v214, s53, v214
    v_cvt_pk_bf16_f32 v133, v213, v214
    v_lshlrev_b32 v215, 16, v134
    v_and_b32 v216, 0xffff0000, v134
    v_mul_f32 v215, s53, v215
    v_mul_f32 v216, s53, v216
    v_cvt_pk_bf16_f32 v134, v215, v216
    v_lshlrev_b32 v217, 16, v135
    v_and_b32 v218, 0xffff0000, v135
    v_mul_f32 v217, s53, v217
    v_mul_f32 v218, s53, v218
    v_cvt_pk_bf16_f32 v135, v217, v218
    v_lshlrev_b32 v211, 16, v136
    v_and_b32 v212, 0xffff0000, v136
    v_mul_f32 v211, s53, v211
    v_mul_f32 v212, s53, v212
    v_cvt_pk_bf16_f32 v136, v211, v212
    v_lshlrev_b32 v213, 16, v137
    v_and_b32 v214, 0xffff0000, v137
    v_mul_f32 v213, s53, v213
    v_mul_f32 v214, s53, v214
    v_cvt_pk_bf16_f32 v137, v213, v214
    v_lshlrev_b32 v215, 16, v138
    v_and_b32 v216, 0xffff0000, v138
    v_mul_f32 v215, s53, v215
    v_mul_f32 v216, s53, v216
    v_cvt_pk_bf16_f32 v138, v215, v216
    v_lshlrev_b32 v217, 16, v139
    v_and_b32 v218, 0xffff0000, v139
    v_mul_f32 v217, s53, v217
    v_mul_f32 v218, s53, v218
    v_cvt_pk_bf16_f32 v139, v217, v218
    v_lshlrev_b32 v211, 16, v140
    v_and_b32 v212, 0xffff0000, v140
    v_mul_f32 v211, s53, v211
    v_mul_f32 v212, s53, v212
    v_cvt_pk_bf16_f32 v140, v211, v212
    v_lshlrev_b32 v213, 16, v141
    v_and_b32 v214, 0xffff0000, v141
    v_mul_f32 v213, s53, v213
    v_mul_f32 v214, s53, v214
    v_cvt_pk_bf16_f32 v141, v213, v214
    v_lshlrev_b32 v215, 16, v142
    v_and_b32 v216, 0xffff0000, v142
    v_mul_f32 v215, s53, v215
    v_mul_f32 v216, s53, v216
    v_cvt_pk_bf16_f32 v142, v215, v216
    v_lshlrev_b32 v217, 16, v143
    v_and_b32 v218, 0xffff0000, v143
    v_mul_f32 v217, s53, v217
    v_mul_f32 v218, s53, v218
    v_cvt_pk_bf16_f32 v143, v217, v218
    v_mov_b32 v0, 0
    v_mov_b32 v1, 0
    v_mov_b32 v2, 0
    v_mov_b32 v3, 0
    v_mov_b32 v4, 0
    v_mov_b32 v5, 0
    v_mov_b32 v6, 0
    v_mov_b32 v7, 0
    v_mov_b32 v8, 0
    v_mov_b32 v9, 0
    v_mov_b32 v10, 0
    v_mov_b32 v11, 0
    v_mov_b32 v12, 0
    v_mov_b32 v13, 0
    v_mov_b32 v14, 0
    v_mov_b32 v15, 0
    v_mov_b32 v16, 0
    v_mov_b32 v17, 0
    v_mov_b32 v18, 0
    v_mov_b32 v19, 0
    v_mov_b32 v20, 0
    v_mov_b32 v21, 0
    v_mov_b32 v22, 0
    v_mov_b32 v23, 0
    v_mov_b32 v24, 0
    v_mov_b32 v25, 0
    v_mov_b32 v26, 0
    v_mov_b32 v27, 0
    v_mov_b32 v28, 0
    v_mov_b32 v29, 0
    v_mov_b32 v30, 0
    v_mov_b32 v31, 0
    v_mov_b32 v32, 0
    v_mov_b32 v33, 0
    v_mov_b32 v34, 0
    v_mov_b32 v35, 0
    v_mov_b32 v36, 0
    v_mov_b32 v37, 0
    v_mov_b32 v38, 0
    v_mov_b32 v39, 0
    v_mov_b32 v40, 0
    v_mov_b32 v41, 0
    v_mov_b32 v42, 0
    v_mov_b32 v43, 0
    v_mov_b32 v44, 0
    v_mov_b32 v45, 0
    v_mov_b32 v46, 0
    v_mov_b32 v47, 0
    v_mov_b32 v48, 0
    v_mov_b32 v49, 0
    v_mov_b32 v50, 0
    v_mov_b32 v51, 0
    v_mov_b32 v52, 0
    v_mov_b32 v53, 0
    v_mov_b32 v54, 0
    v_mov_b32 v55, 0
    v_mov_b32 v56, 0
    v_mov_b32 v57, 0
    v_mov_b32 v58, 0
    v_mov_b32 v59, 0
    v_mov_b32 v60, 0
    v_mov_b32 v61, 0
    v_mov_b32 v62, 0
    v_mov_b32 v63, 0
    v_mov_b32 v96, 0
    v_mov_b32 v97, 0
    v_mov_b32 v98, 0
    v_mov_b32 v99, 0
    v_mov_b32 v100, 0
    v_mov_b32 v101, 0
    v_mov_b32 v102, 0
    v_mov_b32 v103, 0
    v_mov_b32 v104, 0
    v_mov_b32 v105, 0
    v_mov_b32 v106, 0
    v_mov_b32 v107, 0
    v_mov_b32 v108, 0
    v_mov_b32 v109, 0
    v_mov_b32 v110, 0
    v_mov_b32 v111, 0
    v_mov_b32 v207, 0
    s_mov_b32 s42, -1.0
    s_mov_b32 s43, 0xff800000
    s_mov_b32 s57, s61
    s_branch L_MRG_J
L_MRG_X:
    s_barrier
    ds_read_b64 v[176:177], v213
    ds_read_b128 v[64:67], v211 offset:0
    ds_read_b128 v[68:71], v211 offset:1024
    ds_read_b128 v[72:75], v211 offset:2048
    ds_read_b128 v[76:79], v211 offset:3072
    ds_read_b128 v[80:83], v211 offset:4096
    ds_read_b128 v[84:87], v211 offset:5120
    ds_read_b128 v[88:91], v211 offset:6144
    ds_read_b128 v[92:95], v211 offset:7168
    ds_read_b128 v[144:147], v212 offset:0
    ds_read_b128 v[148:151], v212 offset:1024
    ds_read_b128 v[152:155], v212 offset:2048
    ds_read_b128 v[156:159], v212 offset:3072
    ds_read_b128 v[160:163], v212 offset:4096
    ds_read_b128 v[164:167], v212 offset:5120
    ds_read_b128 v[168:171], v212 offset:6144
    ds_read_b128 v[172:175], v212 offset:7168
    s_waitcnt lgkmcnt(15)
    v_min_f32 v184, v96, v176
    v_sub_f32 v185, v184, v96
    v_sub_f32 v186, v184, v176
    v_exp_f32 v185, v185
    v_exp_f32 v186, v186
    v_mov_b32 v96, v184
    v_mov_b32 v97, v184
    v_mov_b32 v98, v184
    v_mov_b32 v99, v184
    v_mov_b32 v100, v184
    v_mov_b32 v101, v184
    v_mov_b32 v102, v184
    v_mov_b32 v103, v184
    v_mov_b32 v104, v184
    v_mov_b32 v105, v184
    v_mov_b32 v106, v184
    v_mov_b32 v107, v184
    v_mov_b32 v108, v184
    v_mov_b32 v109, v184
    v_mov_b32 v110, v184
    v_mov_b32 v111, v184
    v_mul_f32 v207, v207, v185
    v_fma_f32 v207, v177, v186, v207
    v_mul_f32 v0, v0, v185
    v_mul_f32 v1, v1, v185
    v_mul_f32 v2, v2, v185
    v_mul_f32 v3, v3, v185
    v_mul_f32 v4, v4, v185
    v_mul_f32 v5, v5, v185
    v_mul_f32 v6, v6, v185
    v_mul_f32 v7, v7, v185
    v_mul_f32 v8, v8, v185
    v_mul_f32 v9, v9, v185
    v_mul_f32 v10, v10, v185
    v_mul_f32 v11, v11, v185
    v_mul_f32 v12, v12, v185
    v_mul_f32 v13, v13, v185
    v_mul_f32 v14, v14, v185
    v_mul_f32 v15, v15, v185
    v_mul_f32 v16, v16, v185
    v_mul_f32 v17, v17, v185
    v_mul_f32 v18, v18, v185
    v_mul_f32 v19, v19, v185
    v_mul_f32 v20, v20, v185
    v_mul_f32 v21, v21, v185
    v_mul_f32 v22, v22, v185
    v_mul_f32 v23, v23, v185
    v_mul_f32 v24, v24, v185
    v_mul_f32 v25, v25, v185
    v_mul_f32 v26, v26, v185
    v_mul_f32 v27, v27, v185
    v_mul_f32 v28, v28, v185
    v_mul_f32 v29, v29, v185
    v_mul_f32 v30, v30, v185
    v_mul_f32 v31, v31, v185
    v_mul_f32 v32, v32, v185
    v_mul_f32 v33, v33, v185
    v_mul_f32 v34, v34, v185
    v_mul_f32 v35, v35, v185
    v_mul_f32 v36, v36, v185
    v_mul_f32 v37, v37, v185
    v_mul_f32 v38, v38, v185
    v_mul_f32 v39, v39, v185
    v_mul_f32 v40, v40, v185
    v_mul_f32 v41, v41, v185
    v_mul_f32 v42, v42, v185
    v_mul_f32 v43, v43, v185
    v_mul_f32 v44, v44, v185
    v_mul_f32 v45, v45, v185
    v_mul_f32 v46, v46, v185
    v_mul_f32 v47, v47, v185
    v_mul_f32 v48, v48, v185
    v_mul_f32 v49, v49, v185
    v_mul_f32 v50, v50, v185
    v_mul_f32 v51, v51, v185
    v_mul_f32 v52, v52, v185
    v_mul_f32 v53, v53, v185
    v_mul_f32 v54, v54, v185
    v_mul_f32 v55, v55, v185
    v_mul_f32 v56, v56, v185
    v_mul_f32 v57, v57, v185
    v_mul_f32 v58, v58, v185
    v_mul_f32 v59, v59, v185
    v_mul_f32 v60, v60, v185
    v_mul_f32 v61, v61, v185
    v_mul_f32 v62, v62, v185
    v_mul_f32 v63, v63, v185
    s_waitcnt lgkmcnt(8)
    v_fma_f32 v0, v64, v186, v0
    v_fma_f32 v1, v65, v186, v1
    v_fma_f32 v2, v66, v186, v2
    v_fma_f32 v3, v67, v186, v3
    v_fma_f32 v4, v68, v186, v4
    v_fma_f32 v5, v69, v186, v5
    v_fma_f32 v6, v70, v186, v6
    v_fma_f32 v7, v71, v186, v7
    v_fma_f32 v8, v72, v186, v8
    v_fma_f32 v9, v73, v186, v9
    v_fma_f32 v10, v74, v186, v10
    v_fma_f32 v11, v75, v186, v11
    v_fma_f32 v12, v76, v186, v12
    v_fma_f32 v13, v77, v186, v13
    v_fma_f32 v14, v78, v186, v14
    v_fma_f32 v15, v79, v186, v15
    v_fma_f32 v16, v80, v186, v16
    v_fma_f32 v17, v81, v186, v17
    v_fma_f32 v18, v82, v186, v18
    v_fma_f32 v19, v83, v186, v19
    v_fma_f32 v20, v84, v186, v20
    v_fma_f32 v21, v85, v186, v21
    v_fma_f32 v22, v86, v186, v22
    v_fma_f32 v23, v87, v186, v23
    v_fma_f32 v24, v88, v186, v24
    v_fma_f32 v25, v89, v186, v25
    v_fma_f32 v26, v90, v186, v26
    v_fma_f32 v27, v91, v186, v27
    v_fma_f32 v28, v92, v186, v28
    v_fma_f32 v29, v93, v186, v29
    v_fma_f32 v30, v94, v186, v30
    v_fma_f32 v31, v95, v186, v31
    s_waitcnt lgkmcnt(0)
    v_fma_f32 v32, v144, v186, v32
    v_fma_f32 v33, v145, v186, v33
    v_fma_f32 v34, v146, v186, v34
    v_fma_f32 v35, v147, v186, v35
    v_fma_f32 v36, v148, v186, v36
    v_fma_f32 v37, v149, v186, v37
    v_fma_f32 v38, v150, v186, v38
    v_fma_f32 v39, v151, v186, v39
    v_fma_f32 v40, v152, v186, v40
    v_fma_f32 v41, v153, v186, v41
    v_fma_f32 v42, v154, v186, v42
    v_fma_f32 v43, v155, v186, v43
    v_fma_f32 v44, v156, v186, v44
    v_fma_f32 v45, v157, v186, v45
    v_fma_f32 v46, v158, v186, v46
    v_fma_f32 v47, v159, v186, v47
    v_fma_f32 v48, v160, v186, v48
    v_fma_f32 v49, v161, v186, v49
    v_fma_f32 v50, v162, v186, v50
    v_fma_f32 v51, v163, v186, v51
    v_fma_f32 v52, v164, v186, v52
    v_fma_f32 v53, v165, v186, v53
    v_fma_f32 v54, v166, v186, v54
    v_fma_f32 v55, v167, v186, v55
    v_fma_f32 v56, v168, v186, v56
    v_fma_f32 v57, v169, v186, v57
    v_fma_f32 v58, v170, v186, v58
    v_fma_f32 v59, v171, v186, v59
    v_fma_f32 v60, v172, v186, v60
    v_fma_f32 v61, v173, v186, v61
    v_fma_f32 v62, v174, v186, v62
    v_fma_f32 v63, v175, v186, v63
L_MRG_J:
    s_waitcnt vmcnt(0)
    s_barrier
    v_readlane_b32 s72, v225, s32
    s_cmp_ge_u32 s32, s31
    s_cbranch_scc1 L_skipdma_29
    s_mov_b32 m0, s62
    s_add_u32 s32, s32, 1
    s_add_u32 s62, s62, 0x4000
    s_and_b32 s62, s62, 0xffff
    buffer_load_dwordx4 v204, s[12:15], s72 offen lds
    buffer_load_dwordx4 v205, s[12:15], s72 offen offset:1024 lds
L_skipdma_29:
    v_readlane_b32 s73, v225, s33
    s_cmp_ge_u32 s33, s31
    s_cbranch_scc1 L_skipdma_30
    s_mov_b32 m0, s63
    s_add_u32 s33, s33, 1
    s_add_u32 s63, s63, 0x4000
    s_and_b32 s63, s63, 0xffff
    s_or_b32 s63, s63, 0x10000
    buffer_load_dwordx4 v206, s[16:19], s73 offen lds
    buffer_load_dwordx4 v206, s[16:19], s73 offen offset:1024 lds
L_skipdma_30:
    s_cmp_eq_u32 s27, 0
    s_cbranch_scc1 L_G1_NOWAIT
    s_sub_u32 s38, s27, 1
    s_mov_b32 s53, 0x8000
    s_sub_u32 s55, s53, s35
    s_mov_b32 s35, s53
    v_add_u32 v192, s55, v192
    v_add_u32 v193, s55, v193
    v_add_u32 v194, s55, v194
    v_add_u32 v195, s55, v195
    v_add_u32 v196, s55, v196
    v_add_u32 v197, s55, v197
    v_add_u32 v198, s55, v198
    v_add_u32 v199, s55, v199
    s_sub_u32 s55, s53, s36
    s_mov_b32 s36, s53
    v_add_u32 v200, s55, v200
    v_add_u32 v201, s55, v201
    v_add_u32 v202, s55, v202
    v_add_u32 v203, s55, v203
    v_readlane_b32 s72, v225, s32
    v_readlane_b32 s73, v225, s33
    s_nop 15
    s_nop 3
    ds_read_b128 v[144:147], v192 offset:0
    ds_read_b128 v[148:151], v193 offset:0
    ds_read_b128 v[152:155], v194 offset:0
    ds_read_b128 v[156:159], v195 offset:0
    ds_read_b128 v[160:163], v196 offset:0
    ds_read_b128 v[164:167], v197 offset:0
    ds_read_b128 v[168:171], v198 offset:0
    ds_read_b128 v[172:175], v199 offset:0
    s_waitcnt lgkmcnt(6)
    v_mfma_f32_32x32x16_bf16 v[64:79], v[144:147], v[112:115], v[96:111]
    v_mfma_f32_32x32x16_bf16 v[64:79], v[148:151], v[116:119], v[64:79]
    s_waitcnt lgkmcnt(4)
    v_mfma_f32_32x32x16_bf16 v[64:79], v[152:155], v[120:123], v[64:79]
    v_mfma_f32_32x32x16_bf16 v[64:79], v[156:159], v[124:127], v[64:79]
    s_waitcnt lgkmcnt(2)
    v_mfma_f32_32x32x16_bf16 v[64:79], v[160:163], v[128:131], v[64:79]
    v_mfma_f32_32x32x16_bf16 v[64:79], v[164:167], v[132:135], v[64:79]
    s_waitcnt lgkmcnt(0)
    v_mfma_f32_32x32x16_bf16 v[64:79], v[168:171], v[136:139], v[64:79]
    v_mfma_f32_32x32x16_bf16 v[64:79], v[172:175], v[140:143], v[64:79]
    s_cmp_eq_u32 s43, 0
    s_cbranch_scc1 L_noinit_31
    s_nop 9
    v_max3_f32 v211, v64, v65, v66
    v_max3_f32 v211, v211, v67, v68
    v_max3_f32 v211, v211, v69, v70
    v_max3_f32 v211, v211, v71, v72
    v_max3_f32 v211, v211, v73, v74
    v_max3_f32 v211, v211, v75, v76
    v_max3_f32 v211, v211, v77, v78
    v_max_f32 v211, v211, v79
    v_mov_b32 v212, v211
    s_nop 1
    v_permlane32_swap_b32 v211, v212
    v_max_f32 v213, v211, v212
    v_sub_f32 v64, v64, v213
    v_sub_f32 v65, v65, v213
    v_sub_f32 v66, v66, v213
    v_sub_f32 v67, v67, v213
    v_sub_f32 v68, v68, v213
    v_sub_f32 v69, v69, v213
    v_sub_f32 v70, v70, v213
    v_sub_f32 v71, v71, v213
    v_sub_f32 v72, v72, v213
    v_sub_f32 v73, v73, v213
    v_sub_f32 v74, v74, v213
    v_sub_f32 v75, v75, v213
    v_sub_f32 v76, v76, v213
    v_sub_f32 v77, v77, v213
    v_sub_f32 v78, v78, v213
    v_sub_f32 v79, v79, v213
    v_sub_f32 v96, 0, v213
    v_sub_f32 v97, 0, v213
    v_sub_f32 v98, 0, v213
    v_sub_f32 v99, 0, v213
    v_sub_f32 v100, 0, v213
    v_sub_f32 v101, 0, v213
    v_sub_f32 v102, 0, v213
    v_sub_f32 v103, 0, v213
    v_sub_f32 v104, 0, v213
    v_sub_f32 v105, 0, v213
    v_sub_f32 v106, 0, v213
    v_sub_f32 v107, 0, v213
    v_sub_f32 v108, 0, v213
    v_sub_f32 v109, 0, v213
    v_sub_f32 v110, 0, v213
    v_sub_f32 v111, 0, v213
    s_mov_b32 s42, 0x43800000
    s_mov_b32 s43, 0
L_noinit_31:
L_D_FIRST:
    ds_read_b128 v[144:147], v192 offset:8192
    ds_read_b128 v[148:151], v193 offset:8192
    ds_read_b128 v[152:155], v194 offset:8192
    ds_read_b128 v[156:159], v195 offset:8192
    ds_read_b128 v[160:163], v196 offset:8192
    ds_read_b128 v[164:167], v197 offset:8192
    ds_read_b128 v[168:171], v198 offset:8192
    ds_read_b128 v[172:175], v199 offset:8192
    s_nop 0
    v_exp_f32 v184, v64
    v_exp_f32 v185, v65
    v_exp_f32 v186, v66
    v_exp_f32 v187, v67
    v_add_f32 v208, v184, v185
    v_exp_f32 v188, v68
    v_exp_f32 v189, v69
    v_add_f32 v208, v208, v186
    v_cvt_pk_bf16_f32 v176, v184, v185
    v_exp_f32 v190, v70
    v_exp_f32 v191, v71
    v_add_f32 v208, v208, v187
    v_cvt_pk_bf16_f32 v177, v186, v187
    v_exp_f32 v184, v72
    v_add_f32 v208, v208, v188
    v_add_f32 v208, v208, v189
    v_cvt_pk_bf16_f32 v178, v188, v189
    v_exp_f32 v185, v73
    v_add_f32 v208, v208, v190
    v_add_f32 v208, v208, v191
    v_cvt_pk_bf16_f32 v179, v190, v191
    v_exp_f32 v186, v74
    v_add_f32 v208, v208, v184
    s_waitcnt lgkmcnt(6)
    v_mfma_f32_32x32x16_bf16 v[80:95], v[144:147], v[112:115], v[96:111]
    ds_read_b64_tr_b16 v[144:145], v200 offset:0
    ds_read_b64_tr_b16 v[146:147], v200 offset:2048
    v_exp_f32 v187, v75
    v_add_f32 v208, v208, v185
    v_cvt_pk_bf16_f32 v180, v184, v185
    v_mfma_f32_32x32x16_bf16 v[80:95], v[148:151], v[116:119], v[80:95]
    ds_read_b64_tr_b16 v[148:149], v201 offset:0
    ds_read_b64_tr_b16 v[150:151], v201 offset:2048
    v_exp_f32 v188, v76
    v_add_f32 v208, v208, v186
    s_waitcnt lgkmcnt(8)
    v_mfma_f32_32x32x16_bf16 v[80:95], v[152:155], v[120:123], v[80:95]
    ds_read_b64_tr_b16 v[152:153], v202 offset:0
    ds_read_b64_tr_b16 v[154:155], v202 offset:2048
    v_exp_f32 v189, v77
    v_add_f32 v208, v208, v187
    v_cvt_pk_bf16_f32 v181, v186, v187
    v_mfma_f32_32x32x16_bf16 v[80:95], v[156:159], v[124:127], v[80:95]
    ds_read_b64_tr_b16 v[156:157], v203 offset:0
    ds_read_b64_tr_b16 v[158:159], v203 offset:2048
    v_exp_f32 v190, v78
    v_add_f32 v208, v208, v188
    s_waitcnt lgkmcnt(10)
    v_mfma_f32_32x32x16_bf16 v[80:95], v[160:163], v[128:131], v[80:95]
    ds_read_b64_tr_b16 v[160:161], v200 offset:4096
    ds_read_b64_tr_b16 v[162:163], v200 offset:6144
    v_exp_f32 v191, v79
    v_add_f32 v208, v208, v189
    v_cvt_pk_bf16_f32 v182, v188, v189
    v_mfma_f32_32x32x16_bf16 v[80:95], v[164:167], v[132:135], v[80:95]
    ds_read_b64_tr_b16 v[164:165], v201 offset:4096
    ds_read_b64_tr_b16 v[166:167], v201 offset:6144
    v_add_f32 v208, v208, v190
    s_waitcnt lgkmcnt(12)
    v_mfma_f32_32x32x16_bf16 v[80:95], v[168:171], v[136:139], v[80:95]
    ds_read_b64_tr_b16 v[168:169], v202 offset:4096
    ds_read_b64_tr_b16 v[170:171], v202 offset:6144
    v_add_f32 v208, v208, v191
    v_cvt_pk_bf16_f32 v183, v190, v191
    v_mfma_f32_32x32x16_bf16 v[80:95], v[172:175], v[140:143], v[80:95]
    ds_read_b64_tr_b16 v[172:173], v203 offset:4096
    ds_read_b64_tr_b16 v[174:175], v203 offset:6144
    v_cmp_lt_f32 vcc, s42, v208
    s_cbranch_vccnz L_rare_32
L_back_33:
    v_add_f32 v207, v207, v208
    s_cmp_lg_u32 s25, 0
    s_cbranch_scc1 L_D_MID1_Y
L_D_MID1_X:
    s_waitcnt vmcnt(4)
    s_barrier
    s_waitcnt lgkmcnt(12)
    v_mfma_f32_32x32x16_bf16 v[0:15], v[144:147], v[176:179], v[0:15]
    ds_read_b128 v[144:147], v192 offset:16384
    s_mov_b32 m0, s62
    s_add_u32 s62, s62, 0x4000
    buffer_load_dwordx4 v204, s[12:15], s72 offen lds
    v_mfma_f32_32x32x16_bf16 v[16:31], v[148:151], v[176:179], v[16:31]
    ds_read_b128 v[148:151], v193 offset:16384
    s_and_b32 s62, s62, 0xffff
    buffer_load_dwordx4 v205, s[12:15], s72 offen offset:1024 lds
    v_exp_f32 v184, v80
    v_exp_f32 v185, v81
    s_waitcnt lgkmcnt(10)
    v_mfma_f32_32x32x16_bf16 v[32:47], v[152:155], v[176:179], v[32:47]
    ds_read_b128 v[152:155], v194 offset:16384
    s_mov_b32 m0, s63
    s_add_u32 s63, s63, 0x4000
    buffer_load_dwordx4 v206, s[16:19], s73 offen lds
    v_exp_f32 v186, v82
    v_exp_f32 v187, v83
    v_add_f32 v208, v184, v185
    v_mfma_f32_32x32x16_bf16 v[48:63], v[156:159], v[176:179], v[48:63]
    ds_read_b128 v[156:159], v195 offset:16384
    s_and_b32 s63, s63, 0xffff
    buffer_load_dwordx4 v206, s[16:19], s73 offen offset:1024 lds
    v_exp_f32 v188, v84
    v_exp_f32 v189, v85
    v_add_f32 v208, v208, v186
    v_cvt_pk_bf16_f32 v176, v184, v185
    s_waitcnt lgkmcnt(8)
    v_mfma_f32_32x32x16_bf16 v[0:15], v[160:163], v[180:183], v[0:15]
    ds_read_b128 v[160:163], v196 offset:16384
    s_or_b32 s63, s63, 0x10000
    s_add_u32 s32, s32, 1
    v_exp_f32 v190, v86
    v_exp_f32 v191, v87
    v_add_f32 v208, v208, v187
    v_cvt_pk_bf16_f32 v177, v186, v187
    v_mfma_f32_32x32x16_bf16 v[16:31], v[164:167], v[180:183], v[16:31]
    ds_read_b128 v[164:167], v197 offset:16384
    s_add_u32 s33, s33, 1
    v_readlane_b32 s72, v225, s32
    v_exp_f32 v184, v88
    v_add_f32 v208, v208, v188
    v_add_f32 v208, v208, v189
    v_cvt_pk_bf16_f32 v178, v188, v189
    s_waitcnt lgkmcnt(6)
    v_mfma_f32_32x32x16_bf16 v[32:47], v[168:171], v[180:183], v[32:47]
    ds_read_b128 v[168:171], v198 offset:16384
    v_readlane_b32 s73, v225, s33
    v_exp_f32 v185, v89
    v_add_f32 v208, v208, v190
    v_add_f32 v208, v208, v191
    v_cvt_pk_bf16_f32 v179, v190, v191
    v_mfma_f32_32x32x16_bf16 v[48:63], v[172:175], v[180:183], v[48:63]
    ds_read_b128 v[172:175], v199 offset:16384
    v_exp_f32 v186, v90
    v_add_f32 v208, v208, v184
    s_waitcnt lgkmcnt(6)
    v_mfma_f32_32x32x16_bf16 v[64:79], v[144:147], v[112:115], v[96:111]
    ds_read_b64_tr_b16 v[144:145], v200 offset:8192
    ds_read_b64_tr_b16 v[146:147], v200 offset:10240
    v_exp_f32 v187, v91
    v_add_f32 v208, v208, v185
    v_cvt_pk_bf16_f32 v180, v184, v185
    v_mfma_f32_32x32x16_bf16 v[64:79], v[148:151], v[116:119], v[64:79]
    ds_read_b64_tr_b16 v[148:149], v201 offset:8192
    ds_read_b64_tr_b16 v[150:151], v201 offset:10240
    v_exp_f32 v188, v92
    v_add_f32 v208, v208, v186
    s_waitcnt lgkmcnt(8)
    v_mfma_f32_32x32x16_bf16 v[64:79], v[152:155], v[120:123], v[64:79]
    ds_read_b64_tr_b16 v[152:153], v202 offset:8192
    ds_read_b64_tr_b16 v[154:155], v202 offset:10240
    v_exp_f32 v189, v93
    v_add_f32 v208, v208, v187
    v_cvt_pk_bf16_f32 v181, v186, v187
    v_mfma_f32_32x32x16_bf16 v[64:79], v[156:159], v[124:127], v[64:79]
    ds_read_b64_tr_b16 v[156:157], v203 offset:8192
    ds_read_b64_tr_b16 v[158:159], v203 offset:10240
    v_exp_f32 v190, v94
    v_add_f32 v208, v208, v188
    s_waitcnt lgkmcnt(10)
    v_mfma_f32_32x32x16_bf16 v[64:79], v[160:163], v[128:131], v[64:79]
    ds_read_b64_tr_b16 v[160:161], v200 offset:12288
    ds_read_b64_tr_b16 v[162:163], v200 offset:14336
    v_exp_f32 v191, v95
    v_add_f32 v208, v208, v189
    v_cvt_pk_bf16_f32 v182, v188, v189
    v_mfma_f32_32x32x16_bf16 v[64:79], v[164:167], v[132:135], v[64:79]
    ds_read_b64_tr_b16 v[164:165], v201 offset:12288
    ds_read_b64_tr_b16 v[166:167], v201 offset:14336
    v_add_f32 v208, v208, v190
    s_waitcnt lgkmcnt(12)
    v_mfma_f32_32x32x16_bf16 v[64:79], v[168:171], v[136:139], v[64:79]
    ds_read_b64_tr_b16 v[168:169], v202 offset:12288
    ds_read_b64_tr_b16 v[170:171], v202 offset:14336
    v_add_f32 v208, v208, v191
    v_cvt_pk_bf16_f32 v183, v190, v191
    v_mfma_f32_32x32x16_bf16 v[64:79], v[172:175], v[140:143], v[64:79]
    ds_read_b64_tr_b16 v[172:173], v203 offset:12288
    ds_read_b64_tr_b16 v[174:175], v203 offset:14336
    v_cmp_lt_f32 vcc, s42, v208
    s_cbranch_vccnz L_rare_34
L_back_35:
    v_add_f32 v207, v207, v208
L_D_MID2_X:
    s_waitcnt lgkmcnt(12)
    v_mfma_f32_32x32x16_bf16 v[0:15], v[144:147], v[176:179], v[0:15]
    ds_read_b128 v[144:147], v192 offset:24576
    v_mfma_f32_32x32x16_bf16 v[16:31], v[148:151], v[176:179], v[16:31]
    ds_read_b128 v[148:151], v193 offset:24576
    s_nop 3
    v_exp_f32 v184, v64
    v_exp_f32 v185, v65
    s_waitcnt lgkmcnt(10)
    v_mfma_f32_32x32x16_bf16 v[32:47], v[152:155], v[176:179], v[32:47]
    ds_read_b128 v[152:155], v194 offset:24576
    v_exp_f32 v186, v66
    v_exp_f32 v187, v67
    v_add_f32 v208, v184, v185
    v_mfma_f32_32x32x16_bf16 v[48:63], v[156:159], v[176:179], v[48:63]
    ds_read_b128 v[156:159], v195 offset:24576
    v_exp_f32 v188, v68
    v_exp_f32 v189, v69
    v_add_f32 v208, v208, v186
    v_cvt_pk_bf16_f32 v176, v184, v185
    s_waitcnt lgkmcnt(8)
    v_mfma_f32_32x32x16_bf16 v[0:15], v[160:163], v[180:183], v[0:15]
    ds_read_b128 v[160:163], v196 offset:24576
    v_exp_f32 v190, v70
    v_exp_f32 v191, v71
    v_add_f32 v208, v208, v187
    v_cvt_pk_bf16_f32 v177, v186, v187
    v_mfma_f32_32x32x16_bf16 v[16:31], v[164:167], v[180:183], v[16:31]
    ds_read_b128 v[164:167], v197 offset:24576
    v_exp_f32 v184, v72
    v_add_f32 v208, v208, v188
    v_add_f32 v208, v208, v189
    v_cvt_pk_bf16_f32 v178, v188, v189
    s_waitcnt lgkmcnt(6)
    v_mfma_f32_32x32x16_bf16 v[32:47], v[168:171], v[180:183], v[32:47]
    ds_read_b128 v[168:171], v198 offset:24576
    v_exp_f32 v185, v73
    v_add_f32 v208, v208, v190
    v_add_f32 v208, v208, v191
    v_cvt_pk_bf16_f32 v179, v190, v191
    v_mfma_f32_32x32x16_bf16 v[48:63], v[172:175], v[180:183], v[48:63]
    ds_read_b128 v[172:175], v199 offset:24576
    v_exp_f32 v186, v74
    v_add_f32 v208, v208, v184
    s_waitcnt lgkmcnt(6)
    v_mfma_f32_32x32x16_bf16 v[80:95], v[144:147], v[112:115], v[96:111]
    ds_read_b64_tr_b16 v[144:145], v200 offset:16384
    ds_read_b64_tr_b16 v[146:147], v200 offset:18432
    v_exp_f32 v187, v75
    v_add_f32 v208, v208, v185
    v_cvt_pk_bf16_f32 v180, v184, v185
    v_mfma_f32_32x32x16_bf16 v[80:95], v[148:151], v[116:119], v[80:95]
    ds_read_b64_tr_b16 v[148:149], v201 offset:16384
    ds_read_b64_tr_b16 v[150:151], v201 offset:18432
    v_exp_f32 v188, v76
    v_add_f32 v208, v208, v186
    s_waitcnt lgkmcnt(8)
    v_mfma_f32_32x32x16_bf16 v[80:95], v[152:155], v[120:123], v[80:95]
    ds_read_b64_tr_b16 v[152:153], v202 offset:16384
    ds_read_b64_tr_b16 v[154:155], v202 offset:18432
    v_exp_f32 v189, v77
    v_add_f32 v208, v208, v187
    v_cvt_pk_bf16_f32 v181, v186, v187
    v_mfma_f32_32x32x16_bf16 v[80:95], v[156:159], v[124:127], v[80:95]
    ds_read_b64_tr_b16 v[156:157], v203 offset:16384
    ds_read_b64_tr_b16 v[158:159], v203 offset:18432
    v_exp_f32 v190, v78
    v_add_f32 v208, v208, v188
    s_waitcnt lgkmcnt(10)
    v_mfma_f32_32x32x16_bf16 v[80:95], v[160:163], v[128:131], v[80:95]
    ds_read_b64_tr_b16 v[160:161], v200 offset:20480
    ds_read_b64_tr_b16 v[162:163], v200 offset:22528
    v_exp_f32 v191, v79
    v_add_f32 v208, v208, v189
    v_cvt_pk_bf16_f32 v182, v188, v189
    v_mfma_f32_32x32x16_bf16 v[80:95], v[164:167], v[132:135], v[80:95]
    ds_read_b64_tr_b16 v[164:165], v201 offset:20480
    ds_read_b64_tr_b16 v[166:167], v201 offset:22528
    v_add_f32 v208, v208, v190
    s_waitcnt lgkmcnt(12)
    v_mfma_f32_32x32x16_bf16 v[80:95], v[168:171], v[136:139], v[80:95]
    ds_read_b64_tr_b16 v[168:169], v202 offset:20480
    ds_read_b64_tr_b16 v[170:171], v202 offset:22528
    v_add_f32 v208, v208, v191
    v_cvt_pk_bf16_f32 v183, v190, v191
    v_mfma_f32_32x32x16_bf16 v[80:95], v[172:175], v[140:143], v[80:95]
    ds_read_b64_tr_b16 v[172:173], v203 offset:20480
    ds_read_b64_tr_b16 v[174:175], v203 offset:22528
    v_cmp_lt_f32 vcc, s42, v208
    s_cbranch_vccnz L_rare_36
L_back_37:
    v_add_f32 v207, v207, v208
    s_cmp_eq_u32 s38, 0
    s_cbranch_scc1 L_D_LAST
    s_sub_u32 s38, s38, 1
L_D_MID3_X:
    s_xor_b32 s35, s35, 0x8000
    v_xor_b32 v192, 0x8000, v192
    v_xor_b32 v193, 0x8000, v193
    v_xor_b32 v194, 0x8000, v194
    v_xor_b32 v195, 0x8000, v195
    v_xor_b32 v196, 0x8000, v196
    v_xor_b32 v197, 0x8000, v197
    v_xor_b32 v198, 0x8000, v198
    v_xor_b32 v199, 0x8000, v199
    s_waitcnt vmcnt(4)
    s_barrier
    s_waitcnt lgkmcnt(12)
    v_mfma_f32_32x32x16_bf16 v[0:15], v[144:147], v[176:179], v[0:15]
    ds_read_b128 v[144:147], v192 offset:0
    s_mov_b32 m0, s62
    s_add_u32 s62, s62, 0x4000
    buffer_load_dwordx4 v204, s[12:15], s72 offen lds
    v_mfma_f32_32x32x16_bf16 v[16:31], v[148:151], v[176:179], v[16:31]
    ds_read_b128 v[148:151], v193 offset:0
    s_and_b32 s62, s62, 0xffff
    buffer_load_dwordx4 v205, s[12:15], s72 offen offset:1024 lds
    v_exp_f32 v184, v80
    v_exp_f32 v185, v81
    s_waitcnt lgkmcnt(10)
    v_mfma_f32_32x32x16_bf16 v[32:47], v[152:155], v[176:179], v[32:47]
    ds_read_b128 v[152:155], v194 offset:0
    s_mov_b32 m0, s63
    s_add_u32 s63, s63, 0x4000
    buffer_load_dwordx4 v206, s[16:19], s73 offen lds
    v_exp_f32 v186, v82
    v_exp_f32 v187, v83
    v_add_f32 v208, v184, v185
    v_mfma_f32_32x32x16_bf16 v[48:63], v[156:159], v[176:179], v[48:63]
    ds_read_b128 v[156:159], v195 offset:0
    s_and_b32 s63, s63, 0xffff
    buffer_load_dwordx4 v206, s[16:19], s73 offen offset:1024 lds
    v_exp_f32 v188, v84
    v_exp_f32 v189, v85
    v_add_f32 v208, v208, v186
    v_cvt_pk_bf16_f32 v176, v184, v185
    s_waitcnt lgkmcnt(8)
    v_mfma_f32_32x32x16_bf16 v[0:15], v[160:163], v[180:183], v[0:15]
    ds_read_b128 v[160:163], v196 offset:0
    s_or_b32 s63, s63, 0x10000
    s_add_u32 s32, s32, 1
    v_exp_f32 v190, v86
    v_exp_f32 v191, v87
    v_add_f32 v208, v208, v187
    v_cvt_pk_bf16_f32 v177, v186, v187
    v_mfma_f32_32x32x16_bf16 v[16:31], v[164:167], v[180:183], v[16:31]
    ds_read_b128 v[164:167], v197 offset:0
    s_add_u32 s33, s33, 1
    v_readlane_b32 s72, v225, s32
    v_exp_f32 v184, v88
    v_add_f32 v208, v208, v188
    v_add_f32 v208, v208, v189
    v_cvt_pk_bf16_f32 v178, v188, v189
    s_waitcnt lgkmcnt(6)
    v_mfma_f32_32x32x16_bf16 v[32:47], v[168:171], v[180:183], v[32:47]
    ds_read_b128 v[168:171], v198 offset:0
    v_readlane_b32 s73, v225, s33
    v_exp_f32 v185, v89
    v_add_f32 v208, v208, v190
    v_add_f32 v208, v208, v191
    v_cvt_pk_bf16_f32 v179, v190, v191
    v_mfma_f32_32x32x16_bf16 v[48:63], v[172:175], v[180:183], v[48:63]
    ds_read_b128 v[172:175], v199 offset:0
    v_exp_f32 v186, v90
    v_add_f32 v208, v208, v184
    s_waitcnt lgkmcnt(6)
    v_mfma_f32_32x32x16_bf16 v[64:79], v[144:147], v[112:115], v[96:111]
    ds_read_b64_tr_b16 v[144:145], v200 offset:24576
    ds_read_b64_tr_b16 v[146:147], v200 offset:26624
    v_exp_f32 v187, v91
    v_add_f32 v208, v208, v185
    v_cvt_pk_bf16_f32 v180, v184, v185
    v_mfma_f32_32x32x16_bf16 v[64:79], v[148:151], v[116:119], v[64:79]
    ds_read_b64_tr_b16 v[148:149], v201 offset:24576
    ds_read_b64_tr_b16 v[150:151], v201 offset:26624
    v_exp_f32 v188, v92
    v_add_f32 v208, v208, v186
    s_waitcnt lgkmcnt(8)
    v_mfma_f32_32x32x16_bf16 v[64:79], v[152:155], v[120:123], v[64:79]
    ds_read_b64_tr_b16 v[152:153], v202 offset:24576
    ds_read_b64_tr_b16 v[154:155], v202 offset:26624
    v_exp_f32 v189, v93
    v_add_f32 v208, v208, v187
    v_cvt_pk_bf16_f32 v181, v186, v187
    v_mfma_f32_32x32x16_bf16 v[64:79], v[156:159], v[124:127], v[64:79]
    ds_read_b64_tr_b16 v[156:157], v203 offset:24576
    ds_read_b64_tr_b16 v[158:159], v203 offset:26624
    v_exp_f32 v190, v94
    v_add_f32 v208, v208, v188
    s_waitcnt lgkmcnt(10)
    v_mfma_f32_32x32x16_bf16 v[64:79], v[160:163], v[128:131], v[64:79]
    ds_read_b64_tr_b16 v[160:161], v200 offset:28672
    ds_read_b64_tr_b16 v[162:163], v200 offset:30720
    v_exp_f32 v191, v95
    v_add_f32 v208, v208, v189
    v_cvt_pk_bf16_f32 v182, v188, v189
    v_mfma_f32_32x32x16_bf16 v[64:79], v[164:167], v[132:135], v[64:79]
    ds_read_b64_tr_b16 v[164:165], v201 offset:28672
    ds_read_b64_tr_b16 v[166:167], v201 offset:30720
    v_add_f32 v208, v208, v190
    s_waitcnt lgkmcnt(12)
    v_mfma_f32_32x32x16_bf16 v[64:79], v[168:171], v[136:139], v[64:79]
    ds_read_b64_tr_b16 v[168:169], v202 offset:28672
    ds_read_b64_tr_b16 v[170:171], v202 offset:30720
    v_add_f32 v208, v208, v191
    v_cvt_pk_bf16_f32 v183, v190, v191
    v_mfma_f32_32x32x16_bf16 v[64:79], v[172:175], v[140:143], v[64:79]
    ds_read_b64_tr_b16 v[172:173], v203 offset:28672
    ds_read_b64_tr_b16 v[174:175], v203 offset:30720
    v_cmp_lt_f32 vcc, s42, v208
    s_cbranch_vccnz L_rare_38
L_back_39:
    v_add_f32 v207, v207, v208
L_D_MID0_X:
    s_waitcnt lgkmcnt(12)
    v_mfma_f32_32x32x16_bf16 v[0:15], v[144:147], v[176:179], v[0:15]
    ds_read_b128 v[144:147], v192 offset:8192
    v_mfma_f32_32x32x16_bf16 v[16:31], v[148:151], v[176:179], v[16:31]
    ds_read_b128 v[148:151], v193 offset:8192
    s_nop 3
    v_exp_f32 v184, v64
    v_exp_f32 v185, v65
    s_waitcnt lgkmcnt(10)
    v_mfma_f32_32x32x16_bf16 v[32:47], v[152:155], v[176:179], v[32:47]
    ds_read_b128 v[152:155], v194 offset:8192
    v_exp_f32 v186, v66
    v_exp_f32 v187, v67
    v_add_f32 v208, v184, v185
    v_mfma_f32_32x32x16_bf16 v[48:63], v[156:159], v[176:179], v[48:63]
    ds_read_b128 v[156:159], v195 offset:8192
    v_exp_f32 v188, v68
    v_exp_f32 v189, v69
    v_add_f32 v208, v208, v186
    v_cvt_pk_bf16_f32 v176, v184, v185
    s_waitcnt lgkmcnt(8)
    v_mfma_f32_32x32x16_bf16 v[0:15], v[160:163], v[180:183], v[0:15]
    ds_read_b128 v[160:163], v196 offset:8192
    v_exp_f32 v190, v70
    v_exp_f32 v191, v71
    v_add_f32 v208, v208, v187
    v_cvt_pk_bf16_f32 v177, v186, v187
    v_mfma_f32_32x32x16_bf16 v[16:31], v[164:167], v[180:183], v[16:31]
    ds_read_b128 v[164:167], v197 offset:8192
    v_exp_f32 v184, v72
    v_add_f32 v208, v208, v188
    v_add_f32 v208, v208, v189
    v_cvt_pk_bf16_f32 v178, v188, v189
    s_waitcnt lgkmcnt(6)
    v_mfma_f32_32x32x16_bf16 v[32:47], v[168:171], v[180:183], v[32:47]
    ds_read_b128 v[168:171], v198 offset:8192
    v_exp_f32 v185, v73
    v_add_f32 v208, v208, v190
    v_add_f32 v208, v208, v191
    v_cvt_pk_bf16_f32 v179, v190, v191
    s_xor_b32 s36, s36, 0x8000
    v_xor_b32 v200, 0x8000, v200
    v_xor_b32 v201, 0x8000, v201
    v_xor_b32 v202, 0x8000, v202
    v_xor_b32 v203, 0x8000, v203
    v_mfma_f32_32x32x16_bf16 v[48:63], v[172:175], v[180:183], v[48:63]
    ds_read_b128 v[172:175], v199 offset:8192
    v_exp_f32 v186, v74
    v_add_f32 v208, v208, v184
    s_waitcnt lgkmcnt(6)
    v_mfma_f32_32x32x16_bf16 v[80:95], v[144:147], v[112:115], v[96:111]
    ds_read_b64_tr_b16 v[144:145], v200 offset:0
    ds_read_b64_tr_b16 v[146:147], v200 offset:2048
    v_exp_f32 v187, v75
    v_add_f32 v208, v208, v185
    v_cvt_pk_bf16_f32 v180, v184, v185
    v_mfma_f32_32x32x16_bf16 v[80:95], v[148:151], v[116:119], v[80:95]
    ds_read_b64_tr_b16 v[148:149], v201 offset:0
    ds_read_b64_tr_b16 v[150:151], v201 offset:2048
    v_exp_f32 v188, v76
    v_add_f32 v208, v208, v186
    s_waitcnt lgkmcnt(8)
    v_mfma_f32_32x32x16_bf16 v[80:95], v[152:155], v[120:123], v[80:95]
    ds_read_b64_tr_b16 v[152:153], v202 offset:0
    ds_read_b64_tr_b16 v[154:155], v202 offset:2048
    v_exp_f32 v189, v77
    v_add_f32 v208, v208, v187
    v_cvt_pk_bf16_f32 v181, v186, v187
    v_mfma_f32_32x32x16_bf16 v[80:95], v[156:159], v[124:127], v[80:95]
    ds_read_b64_tr_b16 v[156:157], v203 offset:0
    ds_read_b64_tr_b16 v[158:159], v203 offset:2048
    v_exp_f32 v190, v78
    v_add_f32 v208, v208, v188
    s_waitcnt lgkmcnt(10)
    v_mfma_f32_32x32x16_bf16 v[80:95], v[160:163], v[128:131], v[80:95]
    ds_read_b64_tr_b16 v[160:161], v200 offset:4096
    ds_read_b64_tr_b16 v[162:163], v200 offset:6144
    v_exp_f32 v191, v79
    v_add_f32 v208, v208, v189
    v_cvt_pk_bf16_f32 v182, v188, v189
    v_mfma_f32_32x32x16_bf16 v[80:95], v[164:167], v[132:135], v[80:95]
    ds_read_b64_tr_b16 v[164:165], v201 offset:4096
    ds_read_b64_tr_b16 v[166:167], v201 offset:6144
    v_add_f32 v208, v208, v190
    s_waitcnt lgkmcnt(12)
    v_mfma_f32_32x32x16_bf16 v[80:95], v[168:171], v[136:139], v[80:95]
    ds_read_b64_tr_b16 v[168:169], v202 offset:4096
    ds_read_b64_tr_b16 v[170:171], v202 offset:6144
    v_add_f32 v208, v208, v191
    v_cvt_pk_bf16_f32 v183, v190, v191
    v_mfma_f32_32x32x16_bf16 v[80:95], v[172:175], v[140:143], v[80:95]
    ds_read_b64_tr_b16 v[172:173], v203 offset:4096
    ds_read_b64_tr_b16 v[174:175], v203 offset:6144
    v_cmp_lt_f32 vcc, s42, v208
    s_cbranch_vccnz L_rare_40
L_back_41:
    v_add_f32 v207, v207, v208
    s_branch L_D_MID1_X
L_D_MID1_Y:
    s_waitcnt lgkmcnt(12)
    v_mfma_f32_32x32x16_bf16 v[0:15], v[144:147], v[176:179], v[0:15]
    v_mfma_f32_32x32x16_bf16 v[16:31], v[148:151], v[176:179], v[16:31]
    s_nop 5
    v_exp_f32 v184, v80
    v_exp_f32 v185, v81
    s_waitcnt lgkmcnt(8)
    v_mfma_f32_32x32x16_bf16 v[32:47], v[152:155], v[176:179], v[32:47]
    v_exp_f32 v186, v82
    v_exp_f32 v187, v83
    v_add_f32 v208, v184, v185
    v_mfma_f32_32x32x16_bf16 v[48:63], v[156:159], v[176:179], v[48:63]
    v_exp_f32 v188, v84
    v_exp_f32 v189, v85
    v_add_f32 v208, v208, v186
    v_cvt_pk_bf16_f32 v176, v184, v185
    s_waitcnt vmcnt(4)
    s_barrier
    s_waitcnt lgkmcnt(4)
    v_mfma_f32_32x32x16_bf16 v[0:15], v[160:163], v[180:183], v[0:15]
    ds_read_b128 v[144:147], v192 offset:16384
    ds_read_b128 v[148:151], v193 offset:16384
    s_mov_b32 m0, s62
    s_add_u32 s62, s62, 0x4000
    buffer_load_dwordx4 v204, s[12:15], s72 offen lds
    v_exp_f32 v190, v86
    v_exp_f32 v191, v87
    v_add_f32 v208, v208, v187
    v_cvt_pk_bf16_f32 v177, v186, v187
    v_mfma_f32_32x32x16_bf16 v[16:31], v[164:167], v[180:183], v[16:31]
    ds_read_b128 v[152:155], v194 offset:16384
    ds_read_b128 v[156:159], v195 offset:16384
    s_and_b32 s62, s62, 0xffff
    buffer_load_dwordx4 v205, s[12:15], s72 offen offset:1024 lds
    v_exp_f32 v184, v88
    v_add_f32 v208, v208, v188
    v_add_f32 v208, v208, v189
    v_cvt_pk_bf16_f32 v178, v188, v189
    s_waitcnt lgkmcnt(4)
    v_mfma_f32_32x32x16_bf16 v[32:47], v[168:171], v[180:183], v[32:47]
    ds_read_b128 v[160:163], v196 offset:16384
    ds_read_b128 v[164:167], v197 offset:16384
    s_mov_b32 m0, s63
    s_add_u32 s63, s63, 0x4000
    buffer_load_dwordx4 v206, s[16:19], s73 offen lds
    v_exp_f32 v185, v89
    v_add_f32 v208, v208, v190
    v_add_f32 v208, v208, v191
    v_cvt_pk_bf16_f32 v179, v190, v191
    v_mfma_f32_32x32x16_bf16 v[48:63], v[172:175], v[180:183], v[48:63]
    ds_read_b128 v[168:171], v198 offset:16384
    ds_read_b128 v[172:175], v199 offset:16384
    s_and_b32 s63, s63, 0xffff
    buffer_load_dwordx4 v206, s[16:19], s73 offen offset:1024 lds
    v_exp_f32 v186, v90
    v_add_f32 v208, v208, v184
    s_waitcnt lgkmcnt(6)
    v_mfma_f32_32x32x16_bf16 v[64:79], v[144:147], v[112:115], v[96:111]
    ds_read_b64_tr_b16 v[144:145], v200 offset:8192
    ds_read_b64_tr_b16 v[146:147], v200 offset:10240
    s_or_b32 s63, s63, 0x10000
    s_add_u32 s32, s32, 1
    v_exp_f32 v187, v91
    v_add_f32 v208, v208, v185
    v_cvt_pk_bf16_f32 v180, v184, v185
    v_mfma_f32_32x32x16_bf16 v[64:79], v[148:151], v[116:119], v[64:79]
    ds_read_b64_tr_b16 v[148:149], v201 offset:8192
    ds_read_b64_tr_b16 v[150:151], v201 offset:10240
    s_add_u32 s33, s33, 1
    v_readlane_b32 s72, v225, s32
    v_exp_f32 v188, v92
    v_add_f32 v208, v208, v186
    s_waitcnt lgkmcnt(8)
    v_mfma_f32_32x32x16_bf16 v[64:79], v[152:155], v[120:123], v[64:79]
    ds_read_b64_tr_b16 v[152:153], v202 offset:8192
    ds_read_b64_tr_b16 v[154:155], v202 offset:10240
    v_readlane_b32 s73, v225, s33
    v_exp_f32 v189, v93
    v_add_f32 v208, v208, v187
    v_cvt_pk_bf16_f32 v181, v186, v187
    v_mfma_f32_32x32x16_bf16 v[64:79], v[156:159], v[124:127], v[64:79]
    ds_read_b64_tr_b16 v[156:157], v203 offset:8192
    ds_read_b64_tr_b16 v[158:159], v203 offset:10240
    v_exp_f32 v190, v94
    v_add_f32 v208, v208, v188
    s_waitcnt lgkmcnt(10)
    v_mfma_f32_32x32x16_bf16 v[64:79], v[160:163], v[128:131], v[64:79]
    ds_read_b64_tr_b16 v[160:161], v200 offset:12288
    ds_read_b64_tr_b16 v[162:163], v200 offset:14336
    v_exp_f32 v191, v95
    v_add_f32 v208, v208, v189
    v_cvt_pk_bf16_f32 v182, v188, v189
    v_mfma_f32_32x32x16_bf16 v[64:79], v[164:167], v[132:135], v[64:79]
    ds_read_b64_tr_b16 v[164:165], v201 offset:12288
    ds_read_b64_tr_b16 v[166:167], v201 offset:14336
    v_add_f32 v208, v208, v190
    s_waitcnt lgkmcnt(12)
    v_mfma_f32_32x32x16_bf16 v[64:79], v[168:171], v[136:139], v[64:79]
    ds_read_b64_tr_b16 v[168:169], v202 offset:12288
    ds_read_b64_tr_b16 v[170:171], v202 offset:14336
    v_add_f32 v208, v208, v191
    v_cvt_pk_bf16_f32 v183, v190, v191
    v_mfma_f32_32x32x16_bf16 v[64:79], v[172:175], v[140:143], v[64:79]
    ds_read_b64_tr_b16 v[172:173], v203 offset:12288
    ds_read_b64_tr_b16 v[174:175], v203 offset:14336
    v_cmp_lt_f32 vcc, s42, v208
    s_cbranch_vccnz L_rare_42
L_back_43:
    v_add_f32 v207, v207, v208
L_D_MID2_Y:
    s_waitcnt lgkmcnt(12)
    v_mfma_f32_32x32x16_bf16 v[0:15], v[144:147], v[176:179], v[0:15]
    ds_read_b128 v[144:147], v192 offset:24576
    v_mfma_f32_32x32x16_bf16 v[16:31], v[148:151], v[176:179], v[16:31]
    ds_read_b128 v[148:151], v193 offset:24576
    s_nop 3
    v_exp_f32 v184, v64
    v_exp_f32 v185, v65
    s_waitcnt lgkmcnt(10)
    v_mfma_f32_32x32x16_bf16 v[32:47], v[152:155], v[176:179], v[32:47]
    ds_read_b128 v[152:155], v194 offset:24576
    v_exp_f32 v186, v66
    v_exp_f32 v187, v67
    v_add_f32 v208, v184, v185
    v_mfma_f32_32x32x16_bf16 v[48:63], v[156:159], v[176:179], v[48:63]
    ds_read_b128 v[156:159], v195 offset:24576
    v_exp_f32 v188, v68
    v_exp_f32 v189, v69
    v_add_f32 v208, v208, v186
    v_cvt_pk_bf16_f32 v176, v184, v185
    s_waitcnt lgkmcnt(8)
    v_mfma_f32_32x32x16_bf16 v[0:15], v[160:163], v[180:183], v[0:15]
    ds_read_b128 v[160:163], v196 offset:24576
    v_exp_f32 v190, v70
    v_exp_f32 v191, v71
    v_add_f32 v208, v208, v187
    v_cvt_pk_bf16_f32 v177, v186, v187
    v_mfma_f32_32x32x16_bf16 v[16:31], v[164:167], v[180:183], v[16:31]
    ds_read_b128 v[164:167], v197 offset:24576
    v_exp_f32 v184, v72
    v_add_f32 v208, v208, v188
    v_add_f32 v208, v208, v189
    v_cvt_pk_bf16_f32 v178, v188, v189
    s_waitcnt lgkmcnt(6)
    v_mfma_f32_32x32x16_bf16 v[32:47], v[168:171], v[180:183], v[32:47]
    ds_read_b128 v[168:171], v198 offset:24576
    v_exp_f32 v185, v73
    v_add_f32 v208, v208, v190
    v_add_f32 v208, v208, v191
    v_cvt_pk_bf16_f32 v179, v190, v191
    v_mfma_f32_32x32x16_bf16 v[48:63], v[172:175], v[180:183], v[48:63]
    ds_read_b128 v[172:175], v199 offset:24576
    v_exp_f32 v186, v74
    v_add_f32 v208, v208, v184
    s_waitcnt lgkmcnt(6)
    v_mfma_f32_32x32x16_bf16 v[80:95], v[144:147], v[112:115], v[96:111]
    ds_read_b64_tr_b16 v[144:145], v200 offset:16384
    ds_read_b64_tr_b16 v[146:147], v200 offset:18432
    v_exp_f32 v187, v75
    v_add_f32 v208, v208, v185
    v_cvt_pk_bf16_f32 v180, v184, v185
    v_mfma_f32_32x32x16_bf16 v[80:95], v[148:151], v[116:119], v[80:95]
    ds_read_b64_tr_b16 v[148:149], v201 offset:16384
    ds_read_b64_tr_b16 v[150:151], v201 offset:18432
    v_exp_f32 v188, v76
    v_add_f32 v208, v208, v186
    s_waitcnt lgkmcnt(8)
    v_mfma_f32_32x32x16_bf16 v[80:95], v[152:155], v[120:123], v[80:95]
    ds_read_b64_tr_b16 v[152:153], v202 offset:16384
    ds_read_b64_tr_b16 v[154:155], v202 offset:18432
    v_exp_f32 v189, v77
    v_add_f32 v208, v208, v187
    v_cvt_pk_bf16_f32 v181, v186, v187
    v_mfma_f32_32x32x16_bf16 v[80:95], v[156:159], v[124:127], v[80:95]
    ds_read_b64_tr_b16 v[156:157], v203 offset:16384
    ds_read_b64_tr_b16 v[158:159], v203 offset:18432
    v_exp_f32 v190, v78
    v_add_f32 v208, v208, v188
    s_waitcnt lgkmcnt(10)
    v_mfma_f32_32x32x16_bf16 v[80:95], v[160:163], v[128:131], v[80:95]
    ds_read_b64_tr_b16 v[160:161], v200 offset:20480
    ds_read_b64_tr_b16 v[162:163], v200 offset:22528
    v_exp_f32 v191, v79
    v_add_f32 v208, v208, v189
    v_cvt_pk_bf16_f32 v182, v188, v189
    v_mfma_f32_32x32x16_bf16 v[80:95], v[164:167], v[132:135], v[80:95]
    ds_read_b64_tr_b16 v[164:165], v201 offset:20480
    ds_read_b64_tr_b16 v[166:167], v201 offset:22528
    v_add_f32 v208, v208, v190
    s_waitcnt lgkmcnt(12)
    v_mfma_f32_32x32x16_bf16 v[80:95], v[168:171], v[136:139], v[80:95]
    ds_read_b64_tr_b16 v[168:169], v202 offset:20480
    ds_read_b64_tr_b16 v[170:171], v202 offset:22528
    v_add_f32 v208, v208, v191
    v_cvt_pk_bf16_f32 v183, v190, v191
    v_mfma_f32_32x32x16_bf16 v[80:95], v[172:175], v[140:143], v[80:95]
    ds_read_b64_tr_b16 v[172:173], v203 offset:20480
    ds_read_b64_tr_b16 v[174:175], v203 offset:22528
    v_cmp_lt_f32 vcc, s42, v208
    s_cbranch_vccnz L_rare_44
L_back_45:
    v_add_f32 v207, v207, v208
    s_cmp_eq_u32 s38, 0
    s_cbranch_scc1 L_D_LAST
    s_sub_u32 s38, s38, 1
L_D_MID3_Y:
    s_xor_b32 s35, s35, 0x8000
    v_xor_b32 v192, 0x8000, v192
    v_xor_b32 v193, 0x8000, v193
    v_xor_b32 v194, 0x8000, v194
    v_xor_b32 v195, 0x8000, v195
    v_xor_b32 v196, 0x8000, v196
    v_xor_b32 v197, 0x8000, v197
    v_xor_b32 v198, 0x8000, v198
    v_xor_b32 v199, 0x8000, v199
    s_waitcnt lgkmcnt(12)
    v_mfma_f32_32x32x16_bf16 v[0:15], v[144:147], v[176:179], v[0:15]
    v_mfma_f32_32x32x16_bf16 v[16:31], v[148:151], v[176:179], v[16:31]
    v_exp_f32 v184, v80
    v_exp_f32 v185, v81
    s_waitcnt lgkmcnt(8)
    v_mfma_f32_32x32x16_bf16 v[32:47], v[152:155], v[176:179], v[32:47]
    v_exp_f32 v186, v82
    v_exp_f32 v187, v83
    v_add_f32 v208, v184, v185
    v_mfma_f32_32x32x16_bf16 v[48:63], v[156:159], v[176:179], v[48:63]
    v_exp_f32 v188, v84
    v_exp_f32 v189, v85
    v_add_f32 v208, v208, v186
    v_cvt_pk_bf16_f32 v176, v184, v185
    s_waitcnt vmcnt(4)
    s_barrier
    s_waitcnt lgkmcnt(4)
    v_mfma_f32_32x32x16_bf16 v[0:15], v[160:163], v[180:183], v[0:15]
    ds_read_b128 v[144:147], v192 offset:0
    ds_read_b128 v[148:151], v193 offset:0
    s_mov_b32 m0, s62
    s_add_u32 s62, s62, 0x4000
    buffer_load_dwordx4 v204, s[12:15], s72 offen lds
    v_exp_f32 v190, v86
    v_exp_f32 v191, v87
    v_add_f32 v208, v208, v187
    v_cvt_pk_bf16_f32 v177, v186, v187
    v_mfma_f32_32x32x16_bf16 v[16:31], v[164:167], v[180:183], v[16:31]
    ds_read_b128 v[152:155], v194 offset:0
    ds_read_b128 v[156:159], v195 offset:0
    s_and_b32 s62, s62, 0xffff
    buffer_load_dwordx4 v205, s[12:15], s72 offen offset:1024 lds
    v_exp_f32 v184, v88
    v_add_f32 v208, v208, v188
    v_add_f32 v208, v208, v189
    v_cvt_pk_bf16_f32 v178, v188, v189
    s_waitcnt lgkmcnt(4)
    v_mfma_f32_32x32x16_bf16 v[32:47], v[168:171], v[180:183], v[32:47]
    ds_read_b128 v[160:163], v196 offset:0
    ds_read_b128 v[164:167], v197 offset:0
    s_mov_b32 m0, s63
    s_add_u32 s63, s63, 0x4000
    buffer_load_dwordx4 v206, s[16:19], s73 offen lds
    v_exp_f32 v185, v89
    v_add_f32 v208, v208, v190
    v_add_f32 v208, v208, v191
    v_cvt_pk_bf16_f32 v179, v190, v191
    v_mfma_f32_32x32x16_bf16 v[48:63], v[172:175], v[180:183], v[48:63]
    ds_read_b128 v[168:171], v198 offset:0
    ds_read_b128 v[172:175], v199 offset:0
    s_and_b32 s63, s63, 0xffff
    buffer_load_dwordx4 v206, s[16:19], s73 offen offset:1024 lds
    v_exp_f32 v186, v90
    v_add_f32 v208, v208, v184
    s_waitcnt lgkmcnt(6)
    v_mfma_f32_32x32x16_bf16 v[64:79], v[144:147], v[112:115], v[96:111]
    ds_read_b64_tr_b16 v[144:145], v200 offset:24576
    ds_read_b64_tr_b16 v[146:147], v200 offset:26624
    s_or_b32 s63, s63, 0x10000
    s_add_u32 s32, s32, 1
    v_exp_f32 v187, v91
    v_add_f32 v208, v208, v185
    v_cvt_pk_bf16_f32 v180, v184, v185
    v_mfma_f32_32x32x16_bf16 v[64:79], v[148:151], v[116:119], v[64:79]
    ds_read_b64_tr_b16 v[148:149], v201 offset:24576
    ds_read_b64_tr_b16 v[150:151], v201 offset:26624
    s_add_u32 s33, s33, 1
    v_readlane_b32 s72, v225, s32
    v_exp_f32 v188, v92
    v_add_f32 v208, v208, v186
    s_waitcnt lgkmcnt(8)
    v_mfma_f32_32x32x16_bf16 v[64:79], v[152:155], v[120:123], v[64:79]
    ds_read_b64_tr_b16 v[152:153], v202 offset:24576
    ds_read_b64_tr_b16 v[154:155], v202 offset:26624
    v_readlane_b32 s73, v225, s33
    v_exp_f32 v189, v93
    v_add_f32 v208, v208, v187
    v_cvt_pk_bf16_f32 v181, v186, v187
    v_mfma_f32_32x32x16_bf16 v[64:79], v[156:159], v[124:127], v[64:79]
    ds_read_b64_tr_b16 v[156:157], v203 offset:24576
    ds_read_b64_tr_b16 v[158:159], v203 offset:26624
    v_exp_f32 v190, v94
    v_add_f32 v208, v208, v188
    s_waitcnt lgkmcnt(10)
    v_mfma_f32_32x32x16_bf16 v[64:79], v[160:163], v[128:131], v[64:79]
    ds_read_b64_tr_b16 v[160:161], v200 offset:28672
    ds_read_b64_tr_b16 v[162:163], v200 offset:30720
    v_exp_f32 v191, v95
    v_add_f32 v208, v208, v189
    v_cvt_pk_bf16_f32 v182, v188, v189
    v_mfma_f32_32x32x16_bf16 v[64:79], v[164:167], v[132:135], v[64:79]
    ds_read_b64_tr_b16 v[164:165], v201 offset:28672
    ds_read_b64_tr_b16 v[166:167], v201 offset:30720
    v_add_f32 v208, v208, v190
    s_waitcnt lgkmcnt(12)
    v_mfma_f32_32x32x16_bf16 v[64:79], v[168:171], v[136:139], v[64:79]
    ds_read_b64_tr_b16 v[168:169], v202 offset:28672
    ds_read_b64_tr_b16 v[170:171], v202 offset:30720
    v_add_f32 v208, v208, v191
    v_cvt_pk_bf16_f32 v183, v190, v191
    v_mfma_f32_32x32x16_bf16 v[64:79], v[172:175], v[140:143], v[64:79]
    ds_read_b64_tr_b16 v[172:173], v203 offset:28672
    ds_read_b64_tr_b16 v[174:175], v203 offset:30720
    v_cmp_lt_f32 vcc, s42, v208
    s_cbranch_vccnz L_rare_46
L_back_47:
    v_add_f32 v207, v207, v208
L_D_MID0_Y:
    s_waitcnt lgkmcnt(12)
    v_mfma_f32_32x32x16_bf16 v[0:15], v[144:147], v[176:179], v[0:15]
    ds_read_b128 v[144:147], v192 offset:8192
    v_mfma_f32_32x32x16_bf16 v[16:31], v[148:151], v[176:179], v[16:31]
    ds_read_b128 v[148:151], v193 offset:8192
    s_nop 3
    v_exp_f32 v184, v64
    v_exp_f32 v185, v65
    s_waitcnt lgkmcnt(10)
    v_mfma_f32_32x32x16_bf16 v[32:47], v[152:155], v[176:179], v[32:47]
    ds_read_b128 v[152:155], v194 offset:8192
    v_exp_f32 v186, v66
    v_exp_f32 v187, v67
    v_add_f32 v208, v184, v185
    v_mfma_f32_32x32x16_bf16 v[48:63], v[156:159], v[176:179], v[48:63]
    ds_read_b128 v[156:159], v195 offset:8192
    v_exp_f32 v188, v68
    v_exp_f32 v189, v69
    v_add_f32 v208, v208, v186
    v_cvt_pk_bf16_f32 v176, v184, v185
    s_waitcnt lgkmcnt(8)
    v_mfma_f32_32x32x16_bf16 v[0:15], v[160:163], v[180:183], v[0:15]
    ds_read_b128 v[160:163], v196 offset:8192
    v_exp_f32 v190, v70
    v_exp_f32 v191, v71
    v_add_f32 v208, v208, v187
    v_cvt_pk_bf16_f32 v177, v186, v187
    v_mfma_f32_32x32x16_bf16 v[16:31], v[164:167], v[180:183], v[16:31]
    ds_read_b128 v[164:167], v197 offset:8192
    v_exp_f32 v184, v72
    v_add_f32 v208, v208, v188
    v_add_f32 v208, v208, v189
    v_cvt_pk_bf16_f32 v178, v188, v189
    s_waitcnt lgkmcnt(6)
    v_mfma_f32_32x32x16_bf16 v[32:47], v[168:171], v[180:183], v[32:47]
    ds_read_b128 v[168:171], v198 offset:8192
    v_exp_f32 v185, v73
    v_add_f32 v208, v208, v190
    v_add_f32 v208, v208, v191
    v_cvt_pk_bf16_f32 v179, v190, v191
    s_xor_b32 s36, s36, 0x8000
    v_xor_b32 v200, 0x8000, v200
    v_xor_b32 v201, 0x8000, v201
    v_xor_b32 v202, 0x8000, v202
    v_xor_b32 v203, 0x8000, v203
    v_mfma_f32_32x32x16_bf16 v[48:63], v[172:175], v[180:183], v[48:63]
    ds_read_b128 v[172:175], v199 offset:8192
    v_exp_f32 v186, v74
    v_add_f32 v208, v208, v184
    s_waitcnt lgkmcnt(6)
    v_mfma_f32_32x32x16_bf16 v[80:95], v[144:147], v[112:115], v[96:111]
    ds_read_b64_tr_b16 v[144:145], v200 offset:0
    ds_read_b64_tr_b16 v[146:147], v200 offset:2048
    v_exp_f32 v187, v75
    v_add_f32 v208, v208, v185
    v_cvt_pk_bf16_f32 v180, v184, v185
    v_mfma_f32_32x32x16_bf16 v[80:95], v[148:151], v[116:119], v[80:95]
    ds_read_b64_tr_b16 v[148:149], v201 offset:0
    ds_read_b64_tr_b16 v[150:151], v201 offset:2048
    v_exp_f32 v188, v76
    v_add_f32 v208, v208, v186
    s_waitcnt lgkmcnt(8)
    v_mfma_f32_32x32x16_bf16 v[80:95], v[152:155], v[120:123], v[80:95]
    ds_read_b64_tr_b16 v[152:153], v202 offset:0
    ds_read_b64_tr_b16 v[154:155], v202 offset:2048
    v_exp_f32 v189, v77
    v_add_f32 v208, v208, v187
    v_cvt_pk_bf16_f32 v181, v186, v187
    v_mfma_f32_32x32x16_bf16 v[80:95], v[156:159], v[124:127], v[80:95]
    ds_read_b64_tr_b16 v[156:157], v203 offset:0
    ds_read_b64_tr_b16 v[158:159], v203 offset:2048
    v_exp_f32 v190, v78
    v_add_f32 v208, v208, v188
    s_waitcnt lgkmcnt(10)
    v_mfma_f32_32x32x16_bf16 v[80:95], v[160:163], v[128:131], v[80:95]
    ds_read_b64_tr_b16 v[160:161], v200 offset:4096
    ds_read_b64_tr_b16 v[162:163], v200 offset:6144
    v_exp_f32 v191, v79
    v_add_f32 v208, v208, v189
    v_cvt_pk_bf16_f32 v182, v188, v189
    v_mfma_f32_32x32x16_bf16 v[80:95], v[164:167], v[132:135], v[80:95]
    ds_read_b64_tr_b16 v[164:165], v201 offset:4096
    ds_read_b64_tr_b16 v[166:167], v201 offset:6144
    v_add_f32 v208, v208, v190
    s_waitcnt lgkmcnt(12)
    v_mfma_f32_32x32x16_bf16 v[80:95], v[168:171], v[136:139], v[80:95]
    ds_read_b64_tr_b16 v[168:169], v202 offset:4096
    ds_read_b64_tr_b16 v[170:171], v202 offset:6144
    v_add_f32 v208, v208, v191
    v_cvt_pk_bf16_f32 v183, v190, v191
    v_mfma_f32_32x32x16_bf16 v[80:95], v[172:175], v[140:143], v[80:95]
    ds_read_b64_tr_b16 v[172:173], v203 offset:4096
    ds_read_b64_tr_b16 v[174:175], v203 offset:6144
    v_cmp_lt_f32 vcc, s42, v208
    s_cbranch_vccnz L_rare_48
L_back_49:
    v_add_f32 v207, v207, v208
    s_branch L_D_MID1_Y
L_D_LAST:
    s_waitcnt lgkmcnt(12)
    v_mfma_f32_32x32x16_bf16 v[0:15], v[144:147], v[176:179], v[0:15]
    ds_read_b64_tr_b16 v[144:145], v200 offset:24576
    ds_read_b64_tr_b16 v[146:147], v200 offset:26624
    v_mfma_f32_32x32x16_bf16 v[16:31], v[148:151], v[176:179], v[16:31]
    ds_read_b64_tr_b16 v[148:149], v201 offset:24576
    ds_read_b64_tr_b16 v[150:151], v201 offset:26624
    s_nop 1
    v_exp_f32 v184, v80
    v_exp_f32 v185, v81
    s_waitcnt lgkmcnt(12)
    v_mfma_f32_32x32x16_bf16 v[32:47], v[152:155], v[176:179], v[32:47]
    ds_read_b64_tr_b16 v[152:153], v202 offset:24576
    ds_read_b64_tr_b16 v[154:155], v202 offset:26624
    v_exp_f32 v186, v82
    v_exp_f32 v187, v83
    v_add_f32 v208, v184, v185
    v_mfma_f32_32x32x16_bf16 v[48:63], v[156:159], v[176:179], v[48:63]
    ds_read_b64_tr_b16 v[156:157], v203 offset:24576
    ds_read_b64_tr_b16 v[158:159], v203 offset:26624
    v_exp_f32 v188, v84
    v_exp_f32 v189, v85
    v_add_f32 v208, v208, v186
    v_cvt_pk_bf16_f32 v176, v184, v185
    s_waitcnt lgkmcnt(12)
    v_mfma_f32_32x32x16_bf16 v[0:15], v[160:163], v[180:183], v[0:15]
    ds_read_b64_tr_b16 v[160:161], v200 offset:28672
    ds_read_b64_tr_b16 v[162:163], v200 offset:30720
    v_exp_f32 v190, v86
    v_exp_f32 v191, v87
    v_add_f32 v208, v208, v187
    v_cvt_pk_bf16_f32 v177, v186, v187
    v_mfma_f32_32x32x16_bf16 v[16:31], v[164:167], v[180:183], v[16:31]
    ds_read_b64_tr_b16 v[164:165], v201 offset:28672
    ds_read_b64_tr_b16 v[166:167], v201 offset:30720
    v_exp_f32 v184, v88
    v_add_f32 v208, v208, v188
    v_add_f32 v208, v208, v189
    v_cvt_pk_bf16_f32 v178, v188, v189
    s_waitcnt lgkmcnt(12)
    v_mfma_f32_32x32x16_bf16 v[32:47], v[168:171], v[180:183], v[32:47]
    ds_read_b64_tr_b16 v[168:169], v202 offset:28672
    ds_read_b64_tr_b16 v[170:171], v202 offset:30720
    v_exp_f32 v185, v89
    v_add_f32 v208, v208, v190
    v_add_f32 v208, v208, v191
    v_cvt_pk_bf16_f32 v179, v190, v191
    v_mfma_f32_32x32x16_bf16 v[48:63], v[172:175], v[180:183], v[48:63]
    ds_read_b64_tr_b16 v[172:173], v203 offset:28672
    ds_read_b64_tr_b16 v[174:175], v203 offset:30720
    v_exp_f32 v186, v90
    v_add_f32 v208, v208, v184
    v_exp_f32 v187, v91
    v_add_f32 v208, v208, v185
    v_cvt_pk_bf16_f32 v180, v184, v185
    v_exp_f32 v188, v92
    v_add_f32 v208, v208, v186
    v_exp_f32 v189, v93
    v_add_f32 v208, v208, v187
    v_cvt_pk_bf16_f32 v181, v186, v187
    v_exp_f32 v190, v94
    v_add_f32 v208, v208, v188
    v_exp_f32 v191, v95
    v_add_f32 v208, v208, v189
    v_cvt_pk_bf16_f32 v182, v188, v189
    v_add_f32 v208, v208, v190
    v_add_f32 v208, v208, v191
    v_cvt_pk_bf16_f32 v183, v190, v191
    v_cmp_lt_f32 vcc, s42, v208
    s_cbranch_vccnz L_rare_50
L_back_51:
    v_add_f32 v207, v207, v208
    s_waitcnt lgkmcnt(12)
    s_nop 0
    v_mfma_f32_32x32x16_bf16 v[0:15], v[144:147], v[176:179], v[0:15]
    v_mfma_f32_32x32x16_bf16 v[16:31], v[148:151], v[176:179], v[16:31]
    s_waitcnt lgkmcnt(8)
    v_mfma_f32_32x32x16_bf16 v[32:47], v[152:155], v[176:179], v[32:47]
    v_mfma_f32_32x32x16_bf16 v[48:63], v[156:159], v[176:179], v[48:63]
    s_waitcnt lgkmcnt(4)
    v_mfma_f32_32x32x16_bf16 v[0:15], v[160:163], v[180:183], v[0:15]
    v_mfma_f32_32x32x16_bf16 v[16:31], v[164:167], v[180:183], v[16:31]
    s_waitcnt lgkmcnt(0)
    v_mfma_f32_32x32x16_bf16 v[32:47], v[168:171], v[180:183], v[32:47]
    v_mfma_f32_32x32x16_bf16 v[48:63], v[172:175], v[180:183], v[48:63]
    s_nop 15
    s_nop 3
    s_waitcnt vmcnt(0)
    s_barrier
L_G1_NOWAIT:
    v_readlane_b32 s73, v225, s33
    s_cmp_ge_u32 s33, s31
    s_cbranch_scc1 L_skipdma_52
    s_mov_b32 m0, s63
    s_add_u32 s33, s33, 1
    s_add_u32 s63, s63, 0x4000
    s_and_b32 s63, s63, 0xffff
    s_or_b32 s63, s63, 0x10000
    buffer_load_dwordx4 v206, s[16:19], s73 offen lds
    buffer_load_dwordx4 v206, s[16:19], s73 offen offset:1024 lds
L_skipdma_52:
    v_readlane_b32 s72, v225, s32
    s_cmp_ge_u32 s32, s31
    s_cbranch_scc1 L_skipdma_53
    s_mov_b32 m0, s62
    s_add_u32 s32, s32, 1
    s_add_u32 s62, s62, 0x4000
    s_and_b32 s62, s62, 0xffff
    buffer_load_dwordx4 v204, s[12:15], s72 offen lds
    buffer_load_dwordx4 v205, s[12:15], s72 offen offset:1024 lds
L_skipdma_53:
    v_readlane_b32 s73, v225, s33
    s_cmp_ge_u32 s33, s31
    s_cbranch_scc1 L_skipdma_54
    s_mov_b32 m0, s63
    s_add_u32 s33, s33, 1
    s_add_u32 s63, s63, 0x4000
    s_and_b32 s63, s63, 0xffff
    s_or_b32 s63, s63, 0x10000
    buffer_load_dwordx4 v206, s[16:19], s73 offen lds
    buffer_load_dwordx4 v206, s[16:19], s73 offen offset:1024 lds
L_skipdma_54:
    s_add_u32 s53, s28, s25
    s_add_u32 s53, s53, 2
    s_and_b32 s53, s53, 3
    s_lshl_b32 s53, s53, 14
    s_sub_u32 s55, s53, s35
    s_mov_b32 s35, s53
    v_add_u32 v192, s55, v192
    v_add_u32 v193, s55, v193
    v_add_u32 v194, s55, v194
    v_add_u32 v195, s55, v195
    v_add_u32 v196, s55, v196
    v_add_u32 v197, s55, v197
    v_add_u32 v198, s55, v198
    v_add_u32 v199, s55, v199
    s_sub_u32 s55, s53, s36
    s_mov_b32 s36, s53
    v_add_u32 v200, s55, v200
    v_add_u32 v201, s55, v201
    v_add_u32 v202, s55, v202
    v_add_u32 v203, s55, v203
    s_nop 15
    s_nop 3
    ds_read_b128 v[144:147], v192 offset:0
    ds_read_b128 v[148:151], v193 offset:0
    ds_read_b128 v[152:155], v194 offset:0
    ds_read_b128 v[156:159], v195 offset:0
    ds_read_b128 v[160:163], v196 offset:0
    ds_read_b128 v[164:167], v197 offset:0
    ds_read_b128 v[168:171], v198 offset:0
    ds_read_b128 v[172:175], v199 offset:0
    s_waitcnt lgkmcnt(6)
    v_mfma_f32_32x32x16_bf16 v[64:79], v[144:147], v[112:115], v[96:111]
    v_mfma_f32_32x32x16_bf16 v[64:79], v[148:151], v[116:119], v[64:79]
    s_waitcnt lgkmcnt(4)
    v_mfma_f32_32x32x16_bf16 v[64:79], v[152:155], v[120:123], v[64:79]
    v_mfma_f32_32x32x16_bf16 v[64:79], v[156:159], v[124:127], v[64:79]
    s_waitcnt lgkmcnt(2)
    v_mfma_f32_32x32x16_bf16 v[64:79], v[160:163], v[128:131], v[64:79]
    v_mfma_f32_32x32x16_bf16 v[64:79], v[164:167], v[132:135], v[64:79]
    s_waitcnt lgkmcnt(0)
    v_mfma_f32_32x32x16_bf16 v[64:79], v[168:171], v[136:139], v[64:79]
    v_mfma_f32_32x32x16_bf16 v[64:79], v[172:175], v[140:143], v[64:79]
    s_cmp_eq_u32 s58, 1
    s_cbranch_scc1 L_G_SYNC1
L_G_FIRST:
    ds_read_b128 v[144:147], v192 offset:8192
    ds_read_b128 v[148:151], v193 offset:8192
    ds_read_b128 v[152:155], v194 offset:8192
    ds_read_b128 v[156:159], v195 offset:8192
    ds_read_b128 v[160:163], v196 offset:8192
    ds_read_b128 v[164:167], v197 offset:8192
    ds_read_b128 v[168:171], v198 offset:8192
    ds_read_b128 v[172:175], v199 offset:8192
    s_nop 0
    v_exp_f32 v184, v64
    v_exp_f32 v185, v65
    v_exp_f32 v186, v66
    v_exp_f32 v187, v67
    v_add_f32 v208, v184, v185
    v_exp_f32 v188, v68
    v_exp_f32 v189, v69
    v_add_f32 v208, v208, v186
    v_cvt_pk_bf16_f32 v176, v184, v185
    v_exp_f32 v190, v70
    v_exp_f32 v191, v71
    v_add_f32 v208, v208, v187
    v_cvt_pk_bf16_f32 v177, v186, v187
    v_exp_f32 v184, v72
    v_add_f32 v208, v208, v188
    v_add_f32 v208, v208, v189
    v_cvt_pk_bf16_f32 v178, v188, v189
    v_exp_f32 v185, v73
    v_add_f32 v208, v208, v190
    v_add_f32 v208, v208, v191
    v_cvt_pk_bf16_f32 v179, v190, v191
    v_exp_f32 v186, v74
    v_add_f32 v208, v208, v184
    s_waitcnt lgkmcnt(6)
    v_mfma_f32_32x32x16_bf16 v[80:95], v[144:147], v[112:115], v[96:111]
    ds_read_b64_tr_b16 v[144:145], v200 offset:0
    ds_read_b64_tr_b16 v[146:147], v200 offset:2048
    v_exp_f32 v187, v75
    v_add_f32 v208, v208, v185
    v_cvt_pk_bf16_f32 v180, v184, v185
    v_mfma_f32_32x32x16_bf16 v[80:95], v[148:151], v[116:119], v[80:95]
    ds_read_b64_tr_b16 v[148:149], v201 offset:0
    ds_read_b64_tr_b16 v[150:151], v201 offset:2048
    v_exp_f32 v188, v76
    v_add_f32 v208, v208, v186
    s_waitcnt lgkmcnt(8)
    v_mfma_f32_32x32x16_bf16 v[80:95], v[152:155], v[120:123], v[80:95]
    ds_read_b64_tr_b16 v[152:153], v202 offset:0
    ds_read_b64_tr_b16 v[154:155], v202 offset:2048
    v_exp_f32 v189, v77
    v_add_f32 v208, v208, v187
    v_cvt_pk_bf16_f32 v181, v186, v187
    v_mfma_f32_32x32x16_bf16 v[80:95], v[156:159], v[124:127], v[80:95]
    ds_read_b64_tr_b16 v[156:157], v203 offset:0
    ds_read_b64_tr_b16 v[158:159], v203 offset:2048
    v_exp_f32 v190, v78
    v_add_f32 v208, v208, v188
    s_waitcnt lgkmcnt(10)
    v_mfma_f32_32x32x16_bf16 v[80:95], v[160:163], v[128:131], v[80:95]
    ds_read_b64_tr_b16 v[160:161], v200 offset:4096
    ds_read_b64_tr_b16 v[162:163], v200 offset:6144
    v_exp_f32 v191, v79
    v_add_f32 v208, v208, v189
    v_cvt_pk_bf16_f32 v182, v188, v189
    v_mfma_f32_32x32x16_bf16 v[80:95], v[164:167], v[132:135], v[80:95]
    ds_read_b64_tr_b16 v[164:165], v201 offset:4096
    ds_read_b64_tr_b16 v[166:167], v201 offset:6144
    v_add_f32 v208, v208, v190
    s_waitcnt lgkmcnt(12)
    v_mfma_f32_32x32x16_bf16 v[80:95], v[168:171], v[136:139], v[80:95]
    ds_read_b64_tr_b16 v[168:169], v202 offset:4096
    ds_read_b64_tr_b16 v[170:171], v202 offset:6144
    v_add_f32 v208, v208, v191
    v_cvt_pk_bf16_f32 v183, v190, v191
    v_mfma_f32_32x32x16_bf16 v[80:95], v[172:175], v[140:143], v[80:95]
    ds_read_b64_tr_b16 v[172:173], v203 offset:4096
    ds_read_b64_tr_b16 v[174:175], v203 offset:6144
    v_cmp_lt_f32 vcc, s42, v208
    s_cbranch_vccnz L_rare_55
L_back_56:
    v_add_f32 v207, v207, v208
    s_cmp_eq_u32 s58, 2
    s_cbranch_scc1 L_G_SYNC2
L_G_MID1:
    s_xor_b32 s35, s35, 0x8000
    v_xor_b32 v192, 0x8000, v192
    v_xor_b32 v193, 0x8000, v193
    v_xor_b32 v194, 0x8000, v194
    v_xor_b32 v195, 0x8000, v195
    v_xor_b32 v196, 0x8000, v196
    v_xor_b32 v197, 0x8000, v197
    v_xor_b32 v198, 0x8000, v198
    v_xor_b32 v199, 0x8000, v199
    s_waitcnt vmcnt(0)
    s_barrier
    s_waitcnt lgkmcnt(12)
    v_mfma_f32_32x32x16_bf16 v[0:15], v[144:147], v[176:179], v[0:15]
    ds_read_b128 v[144:147], v192 offset:0
    v_mfma_f32_32x32x16_bf16 v[16:31], v[148:151], v[176:179], v[16:31]
    ds_read_b128 v[148:151], v193 offset:0
    v_exp_f32 v184, v80
    v_exp_f32 v185, v81
    s_waitcnt lgkmcnt(10)
    v_mfma_f32_32x32x16_bf16 v[32:47], v[152:155], v[176:179], v[32:47]
    ds_read_b128 v[152:155], v194 offset:0
    v_exp_f32 v186, v82
    v_exp_f32 v187, v83
    v_add_f32 v208, v184, v185
    v_mfma_f32_32x32x16_bf16 v[48:63], v[156:159], v[176:179], v[48:63]
    ds_read_b128 v[156:159], v195 offset:0
    v_exp_f32 v188, v84
    v_exp_f32 v189, v85
    v_add_f32 v208, v208, v186
    v_cvt_pk_bf16_f32 v176, v184, v185
    s_waitcnt lgkmcnt(8)
    v_mfma_f32_32x32x16_bf16 v[0:15], v[160:163], v[180:183], v[0:15]
    ds_read_b128 v[160:163], v196 offset:0
    v_exp_f32 v190, v86
    v_exp_f32 v191, v87
    v_add_f32 v208, v208, v187
    v_cvt_pk_bf16_f32 v177, v186, v187
    v_mfma_f32_32x32x16_bf16 v[16:31], v[164:167], v[180:183], v[16:31]
    ds_read_b128 v[164:167], v197 offset:0
    v_exp_f32 v184, v88
    v_add_f32 v208, v208, v188
    v_add_f32 v208, v208, v189
    v_cvt_pk_bf16_f32 v178, v188, v189
    s_waitcnt lgkmcnt(6)
    v_mfma_f32_32x32x16_bf16 v[32:47], v[168:171], v[180:183], v[32:47]
    ds_read_b128 v[168:171], v198 offset:0
    v_exp_f32 v185, v89
    v_add_f32 v208, v208, v190
    v_add_f32 v208, v208, v191
    v_cvt_pk_bf16_f32 v179, v190, v191
    v_mfma_f32_32x32x16_bf16 v[48:63], v[172:175], v[180:183], v[48:63]
    ds_read_b128 v[172:175], v199 offset:0
    v_exp_f32 v186, v90
    v_add_f32 v208, v208, v184
    s_waitcnt lgkmcnt(6)
    v_mfma_f32_32x32x16_bf16 v[64:79], v[144:147], v[112:115], v[96:111]
    ds_read_b64_tr_b16 v[144:145], v200 offset:8192
    ds_read_b64_tr_b16 v[146:147], v200 offset:10240
    v_exp_f32 v187, v91
    v_add_f32 v208, v208, v185
    v_cvt_pk_bf16_f32 v180, v184, v185
    v_mfma_f32_32x32x16_bf16 v[64:79], v[148:151], v[116:119], v[64:79]
    ds_read_b64_tr_b16 v[148:149], v201 offset:8192
    ds_read_b64_tr_b16 v[150:151], v201 offset:10240
    v_exp_f32 v188, v92
    v_add_f32 v208, v208, v186
    s_waitcnt lgkmcnt(8)
    v_mfma_f32_32x32x16_bf16 v[64:79], v[152:155], v[120:123], v[64:79]
    ds_read_b64_tr_b16 v[152:153], v202 offset:8192
    ds_read_b64_tr_b16 v[154:155], v202 offset:10240
    v_exp_f32 v189, v93
    v_add_f32 v208, v208, v187
    v_cvt_pk_bf16_f32 v181, v186, v187
    v_mfma_f32_32x32x16_bf16 v[64:79], v[156:159], v[124:127], v[64:79]
    ds_read_b64_tr_b16 v[156:157], v203 offset:8192
    ds_read_b64_tr_b16 v[158:159], v203 offset:10240
    v_exp_f32 v190, v94
    v_add_f32 v208, v208, v188
    s_waitcnt lgkmcnt(10)
    v_mfma_f32_32x32x16_bf16 v[64:79], v[160:163], v[128:131], v[64:79]
    ds_read_b64_tr_b16 v[160:161], v200 offset:12288
    ds_read_b64_tr_b16 v[162:163], v200 offset:14336
    v_exp_f32 v191, v95
    v_add_f32 v208, v208, v189
    v_cvt_pk_bf16_f32 v182, v188, v189
    v_mfma_f32_32x32x16_bf16 v[64:79], v[164:167], v[132:135], v[64:79]
    ds_read_b64_tr_b16 v[164:165], v201 offset:12288
    ds_read_b64_tr_b16 v[166:167], v201 offset:14336
    v_add_f32 v208, v208, v190
    s_waitcnt lgkmcnt(12)
    v_mfma_f32_32x32x16_bf16 v[64:79], v[168:171], v[136:139], v[64:79]
    ds_read_b64_tr_b16 v[168:169], v202 offset:12288
    ds_read_b64_tr_b16 v[170:171], v202 offset:14336
    v_add_f32 v208, v208, v191
    v_cvt_pk_bf16_f32 v183, v190, v191
    v_mfma_f32_32x32x16_bf16 v[64:79], v[172:175], v[140:143], v[64:79]
    ds_read_b64_tr_b16 v[172:173], v203 offset:12288
    ds_read_b64_tr_b16 v[174:175], v203 offset:14336
    v_cmp_lt_f32 vcc, s42, v208
    s_cbranch_vccnz L_rare_57
L_back_58:
    v_add_f32 v207, v207, v208
    s_cmp_eq_u32 s58, 3
    s_cbranch_scc1 L_G_LAST2
L_G_MID2:
    s_waitcnt lgkmcnt(12)
    v_mfma_f32_32x32x16_bf16 v[0:15], v[144:147], v[176:179], v[0:15]
    ds_read_b128 v[144:147], v192 offset:8192
    v_mfma_f32_32x32x16_bf16 v[16:31], v[148:151], v[176:179], v[16:31]
    ds_read_b128 v[148:151], v193 offset:8192
    s_nop 3
    v_exp_f32 v184, v64
    v_exp_f32 v185, v65
    s_waitcnt lgkmcnt(10)
    v_mfma_f32_32x32x16_bf16 v[32:47], v[152:155], v[176:179], v[32:47]
    ds_read_b128 v[152:155], v194 offset:8192
    v_exp_f32 v186, v66
    v_exp_f32 v187, v67
    v_add_f32 v208, v184, v185
    v_mfma_f32_32x32x16_bf16 v[48:63], v[156:159], v[176:179], v[48:63]
    ds_read_b128 v[156:159], v195 offset:8192
    v_exp_f32 v188, v68
    v_exp_f32 v189, v69
    v_add_f32 v208, v208, v186
    v_cvt_pk_bf16_f32 v176, v184, v185
    s_waitcnt lgkmcnt(8)
    v_mfma_f32_32x32x16_bf16 v[0:15], v[160:163], v[180:183], v[0:15]
    ds_read_b128 v[160:163], v196 offset:8192
    v_exp_f32 v190, v70
    v_exp_f32 v191, v71
    v_add_f32 v208, v208, v187
    v_cvt_pk_bf16_f32 v177, v186, v187
    v_mfma_f32_32x32x16_bf16 v[16:31], v[164:167], v[180:183], v[16:31]
    ds_read_b128 v[164:167], v197 offset:8192
    v_exp_f32 v184, v72
    v_add_f32 v208, v208, v188
    v_add_f32 v208, v208, v189
    v_cvt_pk_bf16_f32 v178, v188, v189
    s_waitcnt lgkmcnt(6)
    v_mfma_f32_32x32x16_bf16 v[32:47], v[168:171], v[180:183], v[32:47]
    ds_read_b128 v[168:171], v198 offset:8192
    v_exp_f32 v185, v73
    v_add_f32 v208, v208, v190
    v_add_f32 v208, v208, v191
    v_cvt_pk_bf16_f32 v179, v190, v191
    s_xor_b32 s36, s36, 0x8000
    v_xor_b32 v200, 0x8000, v200
    v_xor_b32 v201, 0x8000, v201
    v_xor_b32 v202, 0x8000, v202
    v_xor_b32 v203, 0x8000, v203
    v_mfma_f32_32x32x16_bf16 v[48:63], v[172:175], v[180:183], v[48:63]
    ds_read_b128 v[172:175], v199 offset:8192
    v_exp_f32 v186, v74
    v_add_f32 v208, v208, v184
    s_waitcnt lgkmcnt(6)
    v_mfma_f32_32x32x16_bf16 v[80:95], v[144:147], v[112:115], v[96:111]
    ds_read_b64_tr_b16 v[144:145], v200 offset:0
    ds_read_b64_tr_b16 v[146:147], v200 offset:2048
    v_exp_f32 v187, v75
    v_add_f32 v208, v208, v185
    v_cvt_pk_bf16_f32 v180, v184, v185
    v_mfma_f32_32x32x16_bf16 v[80:95], v[148:151], v[116:119], v[80:95]
    ds_read_b64_tr_b16 v[148:149], v201 offset:0
    ds_read_b64_tr_b16 v[150:151], v201 offset:2048
    v_exp_f32 v188, v76
    v_add_f32 v208, v208, v186
    s_waitcnt lgkmcnt(8)
    v_mfma_f32_32x32x16_bf16 v[80:95], v[152:155], v[120:123], v[80:95]
    ds_read_b64_tr_b16 v[152:153], v202 offset:0
    ds_read_b64_tr_b16 v[154:155], v202 offset:2048
    v_exp_f32 v189, v77
    v_add_f32 v208, v208, v187
    v_cvt_pk_bf16_f32 v181, v186, v187
    v_mfma_f32_32x32x16_bf16 v[80:95], v[156:159], v[124:127], v[80:95]
    ds_read_b64_tr_b16 v[156:157], v203 offset:0
    ds_read_b64_tr_b16 v[158:159], v203 offset:2048
    v_exp_f32 v190, v78
    v_add_f32 v208, v208, v188
    s_waitcnt lgkmcnt(10)
    v_mfma_f32_32x32x16_bf16 v[80:95], v[160:163], v[128:131], v[80:95]
    ds_read_b64_tr_b16 v[160:161], v200 offset:4096
    ds_read_b64_tr_b16 v[162:163], v200 offset:6144
    v_exp_f32 v191, v79
    v_add_f32 v208, v208, v189
    v_cvt_pk_bf16_f32 v182, v188, v189
    v_mfma_f32_32x32x16_bf16 v[80:95], v[164:167], v[132:135], v[80:95]
    ds_read_b64_tr_b16 v[164:165], v201 offset:4096
    ds_read_b64_tr_b16 v[166:167], v201 offset:6144
    v_add_f32 v208, v208, v190
    s_waitcnt lgkmcnt(12)
    v_mfma_f32_32x32x16_bf16 v[80:95], v[168:171], v[136:139], v[80:95]
    ds_read_b64_tr_b16 v[168:169], v202 offset:4096
    ds_read_b64_tr_b16 v[170:171], v202 offset:6144
    v_add_f32 v208, v208, v191
    v_cvt_pk_bf16_f32 v183, v190, v191
    v_mfma_f32_32x32x16_bf16 v[80:95], v[172:175], v[140:143], v[80:95]
    ds_read_b64_tr_b16 v[172:173], v203 offset:4096
    ds_read_b64_tr_b16 v[174:175], v203 offset:6144
    v_cmp_lt_f32 vcc, s42, v208
    s_cbranch_vccnz L_rare_59
L_back_60:
    v_add_f32 v207, v207, v208
L_G_LAST1:
    v_cmp_le_i32_e64 s[64:65], 0, v209
    v_cmp_le_i32_e64 s[66:67], 1, v209
    v_cmp_le_i32_e64 s[68:69], 2, v209
    v_cmp_le_i32_e64 s[70:71], 3, v209
    s_nop 4
    v_cndmask_b32_e64 v80, v210, v80, s[64:65]
    v_cmp_le_i32_e64 s[64:65], 8, v209
    v_cndmask_b32_e64 v81, v210, v81, s[66:67]
    v_cmp_le_i32_e64 s[66:67], 9, v209
    v_cndmask_b32_e64 v82, v210, v82, s[68:69]
    v_cmp_le_i32_e64 s[68:69], 10, v209
    v_cndmask_b32_e64 v83, v210, v83, s[70:71]
    v_cmp_le_i32_e64 s[70:71], 11, v209
    v_cndmask_b32_e64 v84, v210, v84, s[64:65]
    v_cmp_le_i32_e64 s[64:65], 16, v209
    v_cndmask_b32_e64 v85, v210, v85, s[66:67]
    v_cmp_le_i32_e64 s[66:67], 17, v209
    v_cndmask_b32_e64 v86, v210, v86, s[68:69]
    v_cmp_le_i32_e64 s[68:69], 18, v209
    v_cndmask_b32_e64 v87, v210, v87, s[70:71]
    v_cmp_le_i32_e64 s[70:71], 19, v209
    v_cndmask_b32_e64 v88, v210, v88, s[64:65]
    v_cmp_le_i32_e64 s[64:65], 24, v209
    v_cndmask_b32_e64 v89, v210, v89, s[66:67]
    v_cmp_le_i32_e64 s[66:67], 25, v209
    v_cndmask_b32_e64 v90, v210, v90, s[68:69]
    v_cmp_le_i32_e64 s[68:69], 26, v209
    v_cndmask_b32_e64 v91, v210, v91, s[70:71]
    v_cmp_le_i32_e64 s[70:71], 27, v209
    v_cndmask_b32_e64 v92, v210, v92, s[64:65]
    v_cndmask_b32_e64 v93, v210, v93, s[66:67]
    v_cndmask_b32_e64 v94, v210, v94, s[68:69]
    v_cndmask_b32_e64 v95, v210, v95, s[70:71]
    s_waitcnt lgkmcnt(12)
    v_mfma_f32_32x32x16_bf16 v[0:15], v[144:147], v[176:179], v[0:15]
    ds_read_b64_tr_b16 v[144:145], v200 offset:8192
    ds_read_b64_tr_b16 v[146:147], v200 offset:10240
    v_mfma_f32_32x32x16_bf16 v[16:31], v[148:151], v[176:179], v[16:31]
    ds_read_b64_tr_b16 v[148:149], v201 offset:8192
    ds_read_b64_tr_b16 v[150:151], v201 offset:10240
    v_exp_f32 v184, v80
    v_exp_f32 v185, v81
    s_waitcnt lgkmcnt(12)
    v_mfma_f32_32x32x16_bf16 v[32:47], v[152:155], v[176:179], v[32:47]
    ds_read_b64_tr_b16 v[152:153], v202 offset:8192
    ds_read_b64_tr_b16 v[154:155], v202 offset:10240
    v_exp_f32 v186, v82
    v_exp_f32 v187, v83
    v_add_f32 v208, v184, v185
    v_mfma_f32_32x32x16_bf16 v[48:63], v[156:159], v[176:179], v[48:63]
    ds_read_b64_tr_b16 v[156:157], v203 offset:8192
    ds_read_b64_tr_b16 v[158:159], v203 offset:10240
    v_exp_f32 v188, v84
    v_exp_f32 v189, v85
    v_add_f32 v208, v208, v186
    v_cvt_pk_bf16_f32 v176, v184, v185
    s_waitcnt lgkmcnt(12)
    v_mfma_f32_32x32x16_bf16 v[0:15], v[160:163], v[180:183], v[0:15]
    ds_read_b64_tr_b16 v[160:161], v200 offset:12288
    ds_read_b64_tr_b16 v[162:163], v200 offset:14336
    v_exp_f32 v190, v86
    v_exp_f32 v191, v87
    v_add_f32 v208, v208, v187
    v_cvt_pk_bf16_f32 v177, v186, v187
    v_mfma_f32_32x32x16_bf16 v[16:31], v[164:167], v[180:183], v[16:31]
    ds_read_b64_tr_b16 v[164:165], v201 offset:12288
    ds_read_b64_tr_b16 v[166:167], v201 offset:14336
    v_exp_f32 v184, v88
    v_add_f32 v208, v208, v188
    v_add_f32 v208, v208, v189
    v_cvt_pk_bf16_f32 v178, v188, v189
    s_waitcnt lgkmcnt(12)
    v_mfma_f32_32x32x16_bf16 v[32:47], v[168:171], v[180:183], v[32:47]
    ds_read_b64_tr_b16 v[168:169], v202 offset:12288
    ds_read_b64_tr_b16 v[170:171], v202 offset:14336
    v_exp_f32 v185, v89
    v_add_f32 v208, v208, v190
    v_add_f32 v208, v208, v191
    v_cvt_pk_bf16_f32 v179, v190, v191
    v_mfma_f32_32x32x16_bf16 v[48:63], v[172:175], v[180:183], v[48:63]
    ds_read_b64_tr_b16 v[172:173], v203 offset:12288
    ds_read_b64_tr_b16 v[174:175], v203 offset:14336
    v_exp_f32 v186, v90
    v_add_f32 v208, v208, v184
    v_exp_f32 v187, v91
    v_add_f32 v208, v208, v185
    v_cvt_pk_bf16_f32 v180, v184, v185
    v_exp_f32 v188, v92
    v_add_f32 v208, v208, v186
    v_exp_f32 v189, v93
    v_add_f32 v208, v208, v187
    v_cvt_pk_bf16_f32 v181, v186, v187
    v_exp_f32 v190, v94
    v_add_f32 v208, v208, v188
    v_exp_f32 v191, v95
    v_add_f32 v208, v208, v189
    v_cvt_pk_bf16_f32 v182, v188, v189
    v_add_f32 v208, v208, v190
    v_add_f32 v208, v208, v191
    v_cvt_pk_bf16_f32 v183, v190, v191
    v_cmp_lt_f32 vcc, s42, v208
    s_cbranch_vccnz L_rare_61
L_back_62:
    v_add_f32 v207, v207, v208
    s_branch L_G_TAIL
L_G_LAST2:
    s_xor_b32 s36, s36, 0x8000
    v_xor_b32 v200, 0x8000, v200
    v_xor_b32 v201, 0x8000, v201
    v_xor_b32 v202, 0x8000, v202
    v_xor_b32 v203, 0x8000, v203
    v_cmp_le_i32_e64 s[64:65], 0, v209
    v_cmp_le_i32_e64 s[66:67], 1, v209
    v_cmp_le_i32_e64 s[68:69], 2, v209
    v_cmp_le_i32_e64 s[70:71], 3, v209
    v_cndmask_b32_e64 v64, v210, v64, s[64:65]
    v_cmp_le_i32_e64 s[64:65], 8, v209
    v_cndmask_b32_e64 v65, v210, v65, s[66:67]
    v_cmp_le_i32_e64 s[66:67], 9, v209
    v_cndmask_b32_e64 v66, v210, v66, s[68:69]
    v_cmp_le_i32_e64 s[68:69], 10, v209
    v_cndmask_b32_e64 v67, v210, v67, s[70:71]
    v_cmp_le_i32_e64 s[70:71], 11, v209
    v_cndmask_b32_e64 v68, v210, v68, s[64:65]
    v_cmp_le_i32_e64 s[64:65], 16, v209
    v_cndmask_b32_e64 v69, v210, v69, s[66:67]
    v_cmp_le_i32_e64 s[66:67], 17, v209
    v_cndmask_b32_e64 v70, v210, v70, s[68:69]
    v_cmp_le_i32_e64 s[68:69], 18, v209
    v_cndmask_b32_e64 v71, v210, v71, s[70:71]
    v_cmp_le_i32_e64 s[70:71], 19, v209
    v_cndmask_b32_e64 v72, v210, v72, s[64:65]
    v_cmp_le_i32_e64 s[64:65], 24, v209
    v_cndmask_b32_e64 v73, v210, v73, s[66:67]
    v_cmp_le_i32_e64 s[66:67], 25, v209
    v_cndmask_b32_e64 v74, v210, v74, s[68:69]
    v_cmp_le_i32_e64 s[68:69], 26, v209
    v_cndmask_b32_e64 v75, v210, v75, s[70:71]
    v_cmp_le_i32_e64 s[70:71], 27, v209
    v_cndmask_b32_e64 v76, v210, v76, s[64:65]
    v_cndmask_b32_e64 v77, v210, v77, s[66:67]
    v_cndmask_b32_e64 v78, v210, v78, s[68:69]
    v_cndmask_b32_e64 v79, v210, v79, s[70:71]
    s_waitcnt lgkmcnt(12)
    v_mfma_f32_32x32x16_bf16 v[0:15], v[144:147], v[176:179], v[0:15]
    ds_read_b64_tr_b16 v[144:145], v200 offset:0
    ds_read_b64_tr_b16 v[146:147], v200 offset:2048
    v_mfma_f32_32x32x16_bf16 v[16:31], v[148:151], v[176:179], v[16:31]
    ds_read_b64_tr_b16 v[148:149], v201 offset:0
    ds_read_b64_tr_b16 v[150:151], v201 offset:2048
    v_exp_f32 v184, v64
    v_exp_f32 v185, v65
    s_waitcnt lgkmcnt(12)
    v_mfma_f32_32x32x16_bf16 v[32:47], v[152:155], v[176:179], v[32:47]
    ds_read_b64_tr_b16 v[152:153], v202 offset:0
    ds_read_b64_tr_b16 v[154:155], v202 offset:2048
    v_exp_f32 v186, v66
    v_exp_f32 v187, v67
    v_add_f32 v208, v184, v185
    v_mfma_f32_32x32x16_bf16 v[48:63], v[156:159], v[176:179], v[48:63]
    ds_read_b64_tr_b16 v[156:157], v203 offset:0
    ds_read_b64_tr_b16 v[158:159], v203 offset:2048
    v_exp_f32 v188, v68
    v_exp_f32 v189, v69
    v_add_f32 v208, v208, v186
    v_cvt_pk_bf16_f32 v176, v184, v185
    s_waitcnt lgkmcnt(12)
    v_mfma_f32_32x32x16_bf16 v[0:15], v[160:163], v[180:183], v[0:15]
    ds_read_b64_tr_b16 v[160:161], v200 offset:4096
    ds_read_b64_tr_b16 v[162:163], v200 offset:6144
    v_exp_f32 v190, v70
    v_exp_f32 v191, v71
    v_add_f32 v208, v208, v187
    v_cvt_pk_bf16_f32 v177, v186, v187
    v_mfma_f32_32x32x16_bf16 v[16:31], v[164:167], v[180:183], v[16:31]
    ds_read_b64_tr_b16 v[164:165], v201 offset:4096
    ds_read_b64_tr_b16 v[166:167], v201 offset:6144
    v_exp_f32 v184, v72
    v_add_f32 v208, v208, v188
    v_add_f32 v208, v208, v189
    v_cvt_pk_bf16_f32 v178, v188, v189
    s_waitcnt lgkmcnt(12)
    v_mfma_f32_32x32x16_bf16 v[32:47], v[168:171], v[180:183], v[32:47]
    ds_read_b64_tr_b16 v[168:169], v202 offset:4096
    ds_read_b64_tr_b16 v[170:171], v202 offset:6144
    v_exp_f32 v185, v73
    v_add_f32 v208, v208, v190
    v_add_f32 v208, v208, v191
    v_cvt_pk_bf16_f32 v179, v190, v191
    v_mfma_f32_32x32x16_bf16 v[48:63], v[172:175], v[180:183], v[48:63]
    ds_read_b64_tr_b16 v[172:173], v203 offset:4096
    ds_read_b64_tr_b16 v[174:175], v203 offset:6144
    v_exp_f32 v186, v74
    v_add_f32 v208, v208, v184
    v_exp_f32 v187, v75
    v_add_f32 v208, v208, v185
    v_cvt_pk_bf16_f32 v180, v184, v185
    v_exp_f32 v188, v76
    v_add_f32 v208, v208, v186
    v_exp_f32 v189, v77
    v_add_f32 v208, v208, v187
    v_cvt_pk_bf16_f32 v181, v186, v187
    v_exp_f32 v190, v78
    v_add_f32 v208, v208, v188
    v_exp_f32 v191, v79
    v_add_f32 v208, v208, v189
    v_cvt_pk_bf16_f32 v182, v188, v189
    v_add_f32 v208, v208, v190
    v_add_f32 v208, v208, v191
    v_cvt_pk_bf16_f32 v183, v190, v191
    v_cmp_lt_f32 vcc, s42, v208
    s_cbranch_vccnz L_rare_63
L_back_64:
    v_add_f32 v207, v207, v208
    s_branch L_G_TAIL
L_G_SYNC2:
    s_waitcnt vmcnt(0)
    s_barrier
    s_branch L_G_LAST1
L_G_SYNC1:
    s_waitcnt vmcnt(0)
    s_barrier
L_G_ONLY:
    v_cmp_le_i32_e64 s[64:65], 0, v209
    v_cmp_le_i32_e64 s[66:67], 1, v209
    v_cmp_le_i32_e64 s[68:69], 2, v209
    v_cmp_le_i32_e64 s[70:71], 3, v209
    s_nop 4
    v_cndmask_b32_e64 v64, v210, v64, s[64:65]
    v_cmp_le_i32_e64 s[64:65], 8, v209
    v_cndmask_b32_e64 v65, v210, v65, s[66:67]
    v_cmp_le_i32_e64 s[66:67], 9, v209
    v_cndmask_b32_e64 v66, v210, v66, s[68:69]
    v_cmp_le_i32_e64 s[68:69], 10, v209
    v_cndmask_b32_e64 v67, v210, v67, s[70:71]
    v_cmp_le_i32_e64 s[70:71], 11, v209
    v_cndmask_b32_e64 v68, v210, v68, s[64:65]
    v_cmp_le_i32_e64 s[64:65], 16, v209
    v_cndmask_b32_e64 v69, v210, v69, s[66:67]
    v_cmp_le_i32_e64 s[66:67], 17, v209
    v_cndmask_b32_e64 v70, v210, v70, s[68:69]
    v_cmp_le_i32_e64 s[68:69], 18, v209
    v_cndmask_b32_e64 v71, v210, v71, s[70:71]
    v_cmp_le_i32_e64 s[70:71], 19, v209
    v_cndmask_b32_e64 v72, v210, v72, s[64:65]
    v_cmp_le_i32_e64 s[64:65], 24, v209
    v_cndmask_b32_e64 v73, v210, v73, s[66:67]
    v_cmp_le_i32_e64 s[66:67], 25, v209
    v_cndmask_b32_e64 v74, v210, v74, s[68:69]
    v_cmp_le_i32_e64 s[68:69], 26, v209
    v_cndmask_b32_e64 v75, v210, v75, s[70:71]
    v_cmp_le_i32_e64 s[70:71], 27, v209
    v_cndmask_b32_e64 v76, v210, v76, s[64:65]
    v_cndmask_b32_e64 v77, v210, v77, s[66:67]
    v_cndmask_b32_e64 v78, v210, v78, s[68:69]
    v_cndmask_b32_e64 v79, v210, v79, s[70:71]
    ds_read_b64_tr_b16 v[144:145], v200 offset:0
    ds_read_b64_tr_b16 v[146:147], v200 offset:2048
    ds_read_b64_tr_b16 v[148:149], v201 offset:0
    ds_read_b64_tr_b16 v[150:151], v201 offset:2048
    ds_read_b64_tr_b16 v[152:153], v202 offset:0
    ds_read_b64_tr_b16 v[154:155], v202 offset:2048
    ds_read_b64_tr_b16 v[156:157], v203 offset:0
    ds_read_b64_tr_b16 v[158:159], v203 offset:2048
    ds_read_b64_tr_b16 v[160:161], v200 offset:4096
    ds_read_b64_tr_b16 v[162:163], v200 offset:6144
    ds_read_b64_tr_b16 v[164:165], v201 offset:4096
    ds_read_b64_tr_b16 v[166:167], v201 offset:6144
    ds_read_b64_tr_b16 v[168:169], v202 offset:4096
    ds_read_b64_tr_b16 v[170:171], v202 offset:6144
    ds_read_b64_tr_b16 v[172:173], v203 offset:4096
    ds_read_b64_tr_b16 v[174:175], v203 offset:6144
    v_exp_f32 v184, v64
    v_exp_f32 v185, v65
    v_exp_f32 v186, v66
    v_exp_f32 v187, v67
    v_add_f32 v208, v184, v185
    v_exp_f32 v188, v68
    v_exp_f32 v189, v69
    v_add_f32 v208, v208, v186
    v_cvt_pk_bf16_f32 v176, v184, v185
    v_exp_f32 v190, v70
    v_exp_f32 v191, v71
    v_add_f32 v208, v208, v187
    v_cvt_pk_bf16_f32 v177, v186, v187
    v_exp_f32 v184, v72
    v_add_f32 v208, v208, v188
    v_add_f32 v208, v208, v189
    v_cvt_pk_bf16_f32 v178, v188, v189
    v_exp_f32 v185, v73
    v_add_f32 v208, v208, v190
    v_add_f32 v208, v208, v191
    v_cvt_pk_bf16_f32 v179, v190, v191
    v_exp_f32 v186, v74
    v_add_f32 v208, v208, v184
    v_exp_f32 v187, v75
    v_add_f32 v208, v208, v185
    v_cvt_pk_bf16_f32 v180, v184, v185
    v_exp_f32 v188, v76
    v_add_f32 v208, v208, v186
    v_exp_f32 v189, v77
    v_add_f32 v208, v208, v187
    v_cvt_pk_bf16_f32 v181, v186, v187
    v_exp_f32 v190, v78
    v_add_f32 v208, v208, v188
    v_exp_f32 v191, v79
    v_add_f32 v208, v208, v189
    v_cvt_pk_bf16_f32 v182, v188, v189
    v_add_f32 v208, v208, v190
    v_add_f32 v208, v208, v191
    v_cvt_pk_bf16_f32 v183, v190, v191
    v_cmp_lt_f32 vcc, s42, v208
    s_cbranch_vccnz L_rare_65
L_back_66:
    v_add_f32 v207, v207, v208
L_G_TAIL:
    s_waitcnt lgkmcnt(12)
    s_nop 0
    v_mfma_f32_32x32x16_bf16 v[0:15], v[144:147], v[176:179], v[0:15]
    v_mfma_f32_32x32x16_bf16 v[16:31], v[148:151], v[176:179], v[16:31]
    s_waitcnt lgkmcnt(8)
    v_mfma_f32_32x32x16_bf16 v[32:47], v[152:155], v[176:179], v[32:47]
    v_mfma_f32_32x32x16_bf16 v[48:63], v[156:159], v[176:179], v[48:63]
    s_waitcnt lgkmcnt(4)
    v_mfma_f32_32x32x16_bf16 v[0:15], v[160:163], v[180:183], v[0:15]
    v_mfma_f32_32x32x16_bf16 v[16:31], v[164:167], v[180:183], v[16:31]
    s_waitcnt lgkmcnt(0)
    v_mfma_f32_32x32x16_bf16 v[32:47], v[168:171], v[180:183], v[32:47]
    v_mfma_f32_32x32x16_bf16 v[48:63], v[172:175], v[180:183], v[48:63]
    s_nop 15
    s_nop 3
L_FIN:
    v_mov_b32 v211, v207
    v_mov_b32 v212, v207
    s_nop 1
    v_permlane32_swap_b32 v211, v212
    v_add_f32 v211, v211, v212
    v_rcp_f32 v211, v211
    s_add_u32 s54, s57, 4096
    s_lshl_b32 s53, s24, 12
    s_add_u32 s53, s53, 131072
    v_and_b32 v67, 31, v223
    v_lshrrev_b32 v68, 5, v223
    v_and_b32 v64, 7, v67
    v_xor_b32 v64, v64, v68
    v_lshlrev_b32 v67, 7, v67
    v_add_u32 v67, s53, v67
    v_xor_b32 v68, 0, v64
    v_lshl_add_u32 v80, v68, 4, v67
    v_xor_b32 v68, 2, v64
    v_lshl_add_u32 v81, v68, 4, v67
    v_xor_b32 v68, 4, v64
    v_lshl_add_u32 v82, v68, 4, v67
    v_xor_b32 v68, 6, v64
    v_lshl_add_u32 v83, v68, 4, v67
    v_lshrrev_b32 v67, 3, v223
    v_and_b32 v68, 7, v223
    v_xor_b32 v65, v67, v68
    v_lshlrev_b32 v65, 4, v65
    v_lshl_add_u32 v65, v67, 7, v65
    v_add_u32 v65, s53, v65
    v_lshlrev_b32 v66, 4, v68
    v_lshl_add_u32 v66, v67, 8, v66
    v_mul_f32 v0, v0, v211
    v_mul_f32 v1, v1, v211
    v_mul_f32 v2, v2, v211
    v_mul_f32 v3, v3, v211
    v_mul_f32 v4, v4, v211
    v_mul_f32 v5, v5, v211
    v_mul_f32 v6, v6, v211
    v_mul_f32 v7, v7, v211
    v_cvt_pk_bf16_f32 v144, v0, v1
    v_cvt_pk_bf16_f32 v145, v2, v3
    v_cvt_pk_bf16_f32 v146, v4, v5
    v_cvt_pk_bf16_f32 v147, v6, v7
    s_nop 0
    v_permlane32_swap_b32 v144, v146
    v_permlane32_swap_b32 v145, v147
    ds_write_b128 v80, v[144:147]
    v_mul_f32 v8, v8, v211
    v_mul_f32 v9, v9, v211
    v_mul_f32 v10, v10, v211
    v_mul_f32 v11, v11, v211
    v_mul_f32 v12, v12, v211
    v_mul_f32 v13, v13, v211
    v_mul_f32 v14, v14, v211
    v_mul_f32 v15, v15, v211
    v_cvt_pk_bf16_f32 v148, v8, v9
    v_cvt_pk_bf16_f32 v149, v10, v11
    v_cvt_pk_bf16_f32 v150, v12, v13
    v_cvt_pk_bf16_f32 v151, v14, v15
    s_nop 0
    v_permlane32_swap_b32 v148, v150
    v_permlane32_swap_b32 v149, v151
    ds_write_b128 v81, v[148:151]
    v_mul_f32 v16, v16, v211
    v_mul_f32 v17, v17, v211
    v_mul_f32 v18, v18, v211
    v_mul_f32 v19, v19, v211
    v_mul_f32 v20, v20, v211
    v_mul_f32 v21, v21, v211
    v_mul_f32 v22, v22, v211
    v_mul_f32 v23, v23, v211
    v_cvt_pk_bf16_f32 v152, v16, v17
    v_cvt_pk_bf16_f32 v153, v18, v19
    v_cvt_pk_bf16_f32 v154, v20, v21
    v_cvt_pk_bf16_f32 v155, v22, v23
    s_nop 0
    v_permlane32_swap_b32 v152, v154
    v_permlane32_swap_b32 v153, v155
    ds_write_b128 v82, v[152:155]
    v_mul_f32 v24, v24, v211
    v_mul_f32 v25, v25, v211
    v_mul_f32 v26, v26, v211
    v_mul_f32 v27, v27, v211
    v_mul_f32 v28, v28, v211
    v_mul_f32 v29, v29, v211
    v_mul_f32 v30, v30, v211
    v_mul_f32 v31, v31, v211
    v_cvt_pk_bf16_f32 v156, v24, v25
    v_cvt_pk_bf16_f32 v157, v26, v27
    v_cvt_pk_bf16_f32 v158, v28, v29
    v_cvt_pk_bf16_f32 v159, v30, v31
    s_nop 0
    v_permlane32_swap_b32 v156, v158
    v_permlane32_swap_b32 v157, v159
    ds_write_b128 v83, v[156:159]
    s_waitcnt lgkmcnt(0)
    ds_read_b128 v[160:163], v65 offset:0
    ds_read_b128 v[164:167], v65 offset:1024
    ds_read_b128 v[168:171], v65 offset:2048
    ds_read_b128 v[172:175], v65 offset:3072
    s_waitcnt lgkmcnt(3)
    buffer_store_dwordx4 v[160:163], v66, s[20:23], s57 offen offset:0 sc1
    s_waitcnt lgkmcnt(2)
    buffer_store_dwordx4 v[164:167], v66, s[20:23], s57 offen offset:2048 sc1
    s_waitcnt lgkmcnt(1)
    buffer_store_dwordx4 v[168:171], v66, s[20:23], s54 offen offset:0 sc1
    s_waitcnt lgkmcnt(0)
    buffer_store_dwordx4 v[172:175], v66, s[20:23], s54 offen offset:2048 sc1
    v_mul_f32 v32, v32, v211
    v_mul_f32 v33, v33, v211
    v_mul_f32 v34, v34, v211
    v_mul_f32 v35, v35, v211
    v_mul_f32 v36, v36, v211
    v_mul_f32 v37, v37, v211
    v_mul_f32 v38, v38, v211
    v_mul_f32 v39, v39, v211
    v_cvt_pk_bf16_f32 v144, v32, v33
    v_cvt_pk_bf16_f32 v145, v34, v35
    v_cvt_pk_bf16_f32 v146, v36, v37
    v_cvt_pk_bf16_f32 v147, v38, v39
    s_nop 0
    v_permlane32_swap_b32 v144, v146
    v_permlane32_swap_b32 v145, v147
    s_waitcnt lgkmcnt(0)
    ds_write_b128 v80, v[144:147]
    v_mul_f32 v40, v40, v211
    v_mul_f32 v41, v41, v211
    v_mul_f32 v42, v42, v211
    v_mul_f32 v43, v43, v211
    v_mul_f32 v44, v44, v211
    v_mul_f32 v45, v45, v211
    v_mul_f32 v46, v46, v211
    v_mul_f32 v47, v47, v211
    v_cvt_pk_bf16_f32 v148, v40, v41
    v_cvt_pk_bf16_f32 v149, v42, v43
    v_cvt_pk_bf16_f32 v150, v44, v45
    v_cvt_pk_bf16_f32 v151, v46, v47
    s_nop 0
    v_permlane32_swap_b32 v148, v150
    v_permlane32_swap_b32 v149, v151
    ds_write_b128 v81, v[148:151]
    v_mul_f32 v48, v48, v211
    v_mul_f32 v49, v49, v211
    v_mul_f32 v50, v50, v211
    v_mul_f32 v51, v51, v211
    v_mul_f32 v52, v52, v211
    v_mul_f32 v53, v53, v211
    v_mul_f32 v54, v54, v211
    v_mul_f32 v55, v55, v211
    v_cvt_pk_bf16_f32 v152, v48, v49
    v_cvt_pk_bf16_f32 v153, v50, v51
    v_cvt_pk_bf16_f32 v154, v52, v53
    v_cvt_pk_bf16_f32 v155, v54, v55
    s_nop 0
    v_permlane32_swap_b32 v152, v154
    v_permlane32_swap_b32 v153, v155
    ds_write_b128 v82, v[152:155]
    v_mul_f32 v56, v56, v211
    v_mul_f32 v57, v57, v211
    v_mul_f32 v58, v58, v211
    v_mul_f32 v59, v59, v211
    v_mul_f32 v60, v60, v211
    v_mul_f32 v61, v61, v211
    v_mul_f32 v62, v62, v211
    v_mul_f32 v63, v63, v211
    v_cvt_pk_bf16_f32 v156, v56, v57
    v_cvt_pk_bf16_f32 v157, v58, v59
    v_cvt_pk_bf16_f32 v158, v60, v61
    v_cvt_pk_bf16_f32 v159, v62, v63
    s_nop 0
    v_permlane32_swap_b32 v156, v158
    v_permlane32_swap_b32 v157, v159
    ds_write_b128 v83, v[156:159]
    s_waitcnt lgkmcnt(0)
    ds_read_b128 v[160:163], v65 offset:0
    ds_read_b128 v[164:167], v65 offset:1024
    ds_read_b128 v[168:171], v65 offset:2048
    ds_read_b128 v[172:175], v65 offset:3072
    s_waitcnt lgkmcnt(3)
    buffer_store_dwordx4 v[160:163], v66, s[20:23], s57 offen offset:128 sc1
    s_waitcnt lgkmcnt(2)
    buffer_store_dwordx4 v[164:167], v66, s[20:23], s57 offen offset:2176 sc1
    s_waitcnt lgkmcnt(1)
    buffer_store_dwordx4 v[168:171], v66, s[20:23], s54 offen offset:128 sc1
    s_waitcnt lgkmcnt(0)
    buffer_store_dwordx4 v[172:175], v66, s[20:23], s54 offen offset:2176 sc1
L_END:
    s_endpgm
L_rare_5:
    s_call_b64 s[44:45], L_rarebody_0_1
    s_branch L_back_6
L_rare_7:
    s_call_b64 s[44:45], L_rarebody_1_1
    s_branch L_back_8
L_rare_9:
    s_call_b64 s[44:45], L_rarebody_0_1
    s_branch L_back_10
L_rare_11:
    s_call_b64 s[44:45], L_rarebody_1_1
    s_branch L_back_12
L_rare_13:
    s_call_b64 s[44:45], L_rarebody_0_1
    s_branch L_back_14
L_rare_15:
    s_call_b64 s[44:45], L_rarebody_1_0
    s_branch L_back_16
L_rare_17:
    s_call_b64 s[44:45], L_rarebody_0_1
    s_branch L_back_18
L_rare_19:
    s_call_b64 s[44:45], L_rarebody_1_1
    s_branch L_back_20
L_rare_21:
    s_call_b64 s[44:45], L_rarebody_0_1
    s_branch L_back_22
L_rare_23:
    s_call_b64 s[44:45], L_rarebody_1_1
    s_branch L_back_24
L_rare_25:
    s_call_b64 s[44:45], L_rarebody_0_1
    s_branch L_back_26
L_rare_27:
    s_call_b64 s[44:45], L_rarebody_1_0
    s_branch L_back_28
L_rare_32:
    s_call_b64 s[44:45], L_rarebody_0_1
    s_branch L_back_33
L_rare_34:
    s_call_b64 s[44:45], L_rarebody_1_1
    s_branch L_back_35
L_rare_36:
    s_call_b64 s[44:45], L_rarebody_0_1
    s_branch L_back_37
L_rare_38:
    s_call_b64 s[44:45], L_rarebody_1_1
    s_branch L_back_39
L_rare_40:
    s_call_b64 s[44:45], L_rarebody_0_1
    s_branch L_back_41
L_rare_42:
    s_call_b64 s[44:45], L_rarebody_1_1
    s_branch L_back_43
L_rare_44:
    s_call_b64 s[44:45], L_rarebody_0_1
    s_branch L_back_45
L_rare_46:
    s_call_b64 s[44:45], L_rarebody_1_1
    s_branch L_back_47
L_rare_48:
    s_call_b64 s[44:45], L_rarebody_0_1
    s_branch L_back_49
L_rare_50:
    s_call_b64 s[44:45], L_rarebody_1_0
    s_branch L_back_51
L_rare_55:
    s_call_b64 s[44:45], L_rarebody_0_1
    s_branch L_back_56
L_rare_57:
    s_call_b64 s[44:45], L_rarebody_1_1
    s_branch L_back_58
L_rare_59:
    s_call_b64 s[44:45], L_rarebody_0_1
    s_branch L_back_60
L_rare_61:
    s_call_b64 s[44:45], L_rarebody_1_0
    s_branch L_back_62
L_rare_63:
    s_call_b64 s[44:45], L_rarebody_0_0
    s_branch L_back_64
L_rare_65:
    s_call_b64 s[44:45], L_rarebody_0_0
    s_branch L_back_66
L_rarebody_0_0:
    s_nop 15
    s_nop 3
    v_max3_f32 v211, v64, v65, v66
    v_max3_f32 v211, v211, v67, v68
    v_max3_f32 v211, v211, v69, v70
    v_max3_f32 v211, v211, v71, v72
    v_max3_f32 v211, v211, v73, v74
    v_max3_f32 v211, v211, v75, v76
    v_max3_f32 v211, v211, v77, v78
    v_max_f32 v211, v211, v79
    v_mov_b32 v212, v211
    s_nop 1
    v_permlane32_swap_b32 v211, v212
    v_max3_f32 v213, v211, v212, s43
    v_max_f32 v211, 0, v213
    v_exp_f32_e64 v214, -v211
    v_sub_f32 v96, v96, v213
    v_sub_f32 v97, v97, v213
    v_sub_f32 v98, v98, v213
    v_sub_f32 v99, v99, v213
    v_sub_f32 v100, v100, v213
    v_sub_f32 v101, v101, v213
    v_sub_f32 v102, v102, v213
    v_sub_f32 v103, v103, v213
    v_sub_f32 v104, v104, v213
    v_sub_f32 v105, v105, v213
    v_sub_f32 v106, v106, v213
    v_sub_f32 v107, v107, v213
    v_sub_f32 v108, v108, v213
    v_sub_f32 v109, v109, v213
    v_sub_f32 v110, v110, v213
    v_sub_f32 v111, v111, v213
    v_sub_f32 v64, v64, v213
    v_sub_f32 v65, v65, v213
    v_sub_f32 v66, v66, v213
    v_sub_f32 v67, v67, v213
    v_sub_f32 v68, v68, v213
    v_sub_f32 v69, v69, v213
    v_sub_f32 v70, v70, v213
    v_sub_f32 v71, v71, v213
    v_sub_f32 v72, v72, v213
    v_sub_f32 v73, v73, v213
    v_sub_f32 v74, v74, v213
    v_sub_f32 v75, v75, v213
    v_sub_f32 v76, v76, v213
    v_sub_f32 v77, v77, v213
    v_sub_f32 v78, v78, v213
    v_sub_f32 v79, v79, v213
    s_cmp_lg_u32 s43, 0
    s_cbranch_scc1 L_norescale_67
    v_mul_f32 v207, v207, v214
    v_mul_f32 v0, v0, v214
    v_mul_f32 v1, v1, v214
    v_mul_f32 v2, v2, v214
    v_mul_f32 v3, v3, v214
    v_mul_f32 v4, v4, v214
    v_mul_f32 v5, v5, v214
    v_mul_f32 v6, v6, v214
    v_mul_f32 v7, v7, v214
    v_mul_f32 v8, v8, v214
    v_mul_f32 v9, v9, v214
    v_mul_f32 v10, v10, v214
    v_mul_f32 v11, v11, v214
    v_mul_f32 v12, v12, v214
    v_mul_f32 v13, v13, v214
    v_mul_f32 v14, v14, v214
    v_mul_f32 v15, v15, v214
    v_mul_f32 v16, v16, v214
    v_mul_f32 v17, v17, v214
    v_mul_f32 v18, v18, v214
    v_mul_f32 v19, v19, v214
    v_mul_f32 v20, v20, v214
    v_mul_f32 v21, v21, v214
    v_mul_f32 v22, v22, v214
    v_mul_f32 v23, v23, v214
    v_mul_f32 v24, v24, v214
    v_mul_f32 v25, v25, v214
    v_mul_f32 v26, v26, v214
    v_mul_f32 v27, v27, v214
    v_mul_f32 v28, v28, v214
    v_mul_f32 v29, v29, v214
    v_mul_f32 v30, v30, v214
    v_mul_f32 v31, v31, v214
    v_mul_f32 v32, v32, v214
    v_mul_f32 v33, v33, v214
    v_mul_f32 v34, v34, v214
    v_mul_f32 v35, v35, v214
    v_mul_f32 v36, v36, v214
    v_mul_f32 v37, v37, v214
    v_mul_f32 v38, v38, v214
    v_mul_f32 v39, v39, v214
    v_mul_f32 v40, v40, v214
    v_mul_f32 v41, v41, v214
    v_mul_f32 v42, v42, v214
    v_mul_f32 v43, v43, v214
    v_mul_f32 v44, v44, v214
    v_mul_f32 v45, v45, v214
    v_mul_f32 v46, v46, v214
    v_mul_f32 v47, v47, v214
    v_mul_f32 v48, v48, v214
    v_mul_f32 v49, v49, v214
    v_mul_f32 v50, v50, v214
    v_mul_f32 v51, v51, v214
    v_mul_f32 v52, v52, v214
    v_mul_f32 v53, v53, v214
    v_mul_f32 v54, v54, v214
    v_mul_f32 v55, v55, v214
    v_mul_f32 v56, v56, v214
    v_mul_f32 v57, v57, v214
    v_mul_f32 v58, v58, v214
    v_mul_f32 v59, v59, v214
    v_mul_f32 v60, v60, v214
    v_mul_f32 v61, v61, v214
    v_mul_f32 v62, v62, v214
    v_mul_f32 v63, v63, v214
L_norescale_67:
    v_exp_f32 v184, v64
    v_exp_f32 v185, v65
    v_exp_f32 v186, v66
    v_exp_f32 v187, v67
    v_exp_f32 v188, v68
    v_exp_f32 v189, v69
    v_exp_f32 v190, v70
    v_exp_f32 v191, v71
    v_add_f32 v208, v184, v185
    v_add_f32 v208, v208, v186
    v_add_f32 v208, v208, v187
    v_add_f32 v208, v208, v188
    v_add_f32 v208, v208, v189
    v_add_f32 v208, v208, v190
    v_add_f32 v208, v208, v191
    v_cvt_pk_bf16_f32 v176, v184, v185
    v_cvt_pk_bf16_f32 v177, v186, v187
    v_cvt_pk_bf16_f32 v178, v188, v189
    v_cvt_pk_bf16_f32 v179, v190, v191
    v_exp_f32 v184, v72
    v_exp_f32 v185, v73
    v_exp_f32 v186, v74
    v_exp_f32 v187, v75
    v_exp_f32 v188, v76
    v_exp_f32 v189, v77
    v_exp_f32 v190, v78
    v_exp_f32 v191, v79
    v_add_f32 v208, v208, v184
    v_add_f32 v208, v208, v185
    v_add_f32 v208, v208, v186
    v_add_f32 v208, v208, v187
    v_add_f32 v208, v208, v188
    v_add_f32 v208, v208, v189
    v_add_f32 v208, v208, v190
    v_add_f32 v208, v208, v191
    v_cvt_pk_bf16_f32 v180, v184, v185
    v_cvt_pk_bf16_f32 v181, v186, v187
    v_cvt_pk_bf16_f32 v182, v188, v189
    v_cvt_pk_bf16_f32 v183, v190, v191
    s_mov_b32 s42, 0x43800000
    s_mov_b32 s43, 0
    s_nop 1
    s_setpc_b64 s[44:45]
L_rarebody_0_1:
    s_nop 15
    s_nop 3
    v_max3_f32 v211, v64, v65, v66
    v_max3_f32 v211, v211, v67, v68
    v_max3_f32 v211, v211, v69, v70
    v_max3_f32 v211, v211, v71, v72
    v_max3_f32 v211, v211, v73, v74
    v_max3_f32 v211, v211, v75, v76
    v_max3_f32 v211, v211, v77, v78
    v_max_f32 v211, v211, v79
    v_mov_b32 v212, v211
    s_nop 1
    v_permlane32_swap_b32 v211, v212
    v_max3_f32 v213, v211, v212, s43
    v_max_f32 v211, 0, v213
    v_exp_f32_e64 v214, -v211
    v_sub_f32 v96, v96, v213
    v_sub_f32 v97, v97, v213
    v_sub_f32 v98, v98, v213
    v_sub_f32 v99, v99, v213
    v_sub_f32 v100, v100, v213
    v_sub_f32 v101, v101, v213
    v_sub_f32 v102, v102, v213
    v_sub_f32 v103, v103, v213
    v_sub_f32 v104, v104, v213
    v_sub_f32 v105, v105, v213
    v_sub_f32 v106, v106, v213
    v_sub_f32 v107, v107, v213
    v_sub_f32 v108, v108, v213
    v_sub_f32 v109, v109, v213
    v_sub_f32 v110, v110, v213
    v_sub_f32 v111, v111, v213
    v_sub_f32 v64, v64, v213
    v_sub_f32 v65, v65, v213
    v_sub_f32 v66, v66, v213
    v_sub_f32 v67, v67, v213
    v_sub_f32 v68, v68, v213
    v_sub_f32 v69, v69, v213
    v_sub_f32 v70, v70, v213
    v_sub_f32 v71, v71, v213
    v_sub_f32 v72, v72, v213
    v_sub_f32 v73, v73, v213
    v_sub_f32 v74, v74, v213
    v_sub_f32 v75, v75, v213
    v_sub_f32 v76, v76, v213
    v_sub_f32 v77, v77, v213
    v_sub_f32 v78, v78, v213
    v_sub_f32 v79, v79, v213
    v_sub_f32 v80, v80, v213
    v_sub_f32 v81, v81, v213
    v_sub_f32 v82, v82, v213
    v_sub_f32 v83, v83, v213
    v_sub_f32 v84, v84, v213
    v_sub_f32 v85, v85, v213
    v_sub_f32 v86, v86, v213
    v_sub_f32 v87, v87, v213
    v_sub_f32 v88, v88, v213
    v_sub_f32 v89, v89, v213
    v_sub_f32 v90, v90, v213
    v_sub_f32 v91, v91, v213
    v_sub_f32 v92, v92, v213
    v_sub_f32 v93, v93, v213
    v_sub_f32 v94, v94, v213
    v_sub_f32 v95, v95, v213
    s_cmp_lg_u32 s43, 0
    s_cbranch_scc1 L_norescale_68
    v_mul_f32 v207, v207, v214
    v_mul_f32 v0, v0, v214
    v_mul_f32 v1, v1, v214
    v_mul_f32 v2, v2, v214
    v_mul_f32 v3, v3, v214
    v_mul_f32 v4, v4, v214
    v_mul_f32 v5, v5, v214
    v_mul_f32 v6, v6, v214
    v_mul_f32 v7, v7, v214
    v_mul_f32 v8, v8, v214
    v_mul_f32 v9, v9, v214
    v_mul_f32 v10, v10, v214
    v_mul_f32 v11, v11, v214
    v_mul_f32 v12, v12, v214
    v_mul_f32 v13, v13, v214
    v_mul_f32 v14, v14, v214
    v_mul_f32 v15, v15, v214
    v_mul_f32 v16, v16, v214
    v_mul_f32 v17, v17, v214
    v_mul_f32 v18, v18, v214
    v_mul_f32 v19, v19, v214
    v_mul_f32 v20, v20, v214
    v_mul_f32 v21, v21, v214
    v_mul_f32 v22, v22, v214
    v_mul_f32 v23, v23, v214
    v_mul_f32 v24, v24, v214
    v_mul_f32 v25, v25, v214
    v_mul_f32 v26, v26, v214
    v_mul_f32 v27, v27, v214
    v_mul_f32 v28, v28, v214
    v_mul_f32 v29, v29, v214
    v_mul_f32 v30, v30, v214
    v_mul_f32 v31, v31, v214
    v_mul_f32 v32, v32, v214
    v_mul_f32 v33, v33, v214
    v_mul_f32 v34, v34, v214
    v_mul_f32 v35, v35, v214
    v_mul_f32 v36, v36, v214
    v_mul_f32 v37, v37, v214
    v_mul_f32 v38, v38, v214
    v_mul_f32 v39, v39, v214
    v_mul_f32 v40, v40, v214
    v_mul_f32 v41, v41, v214
    v_mul_f32 v42, v42, v214
    v_mul_f32 v43, v43, v214
    v_mul_f32 v44, v44, v214
    v_mul_f32 v45, v45, v214
    v_mul_f32 v46, v46, v214
    v_mul_f32 v47, v47, v214
    v_mul_f32 v48, v48, v214
    v_mul_f32 v49, v49, v214
    v_mul_f32 v50, v50, v214
    v_mul_f32 v51, v51, v214
    v_mul_f32 v52, v52, v214
    v_mul_f32 v53, v53, v214
    v_mul_f32 v54, v54, v214
    v_mul_f32 v55, v55, v214
    v_mul_f32 v56, v56, v214
    v_mul_f32 v57, v57, v214
    v_mul_f32 v58, v58, v214
    v_mul_f32 v59, v59, v214
    v_mul_f32 v60, v60, v214
    v_mul_f32 v61, v61, v214
    v_mul_f32 v62, v62, v214
    v_mul_f32 v63, v63, v214
L_norescale_68:
    v_exp_f32 v184, v64
    v_exp_f32 v185, v65
    v_exp_f32 v186, v66
    v_exp_f32 v187, v67
    v_exp_f32 v188, v68
    v_exp_f32 v189, v69
    v_exp_f32 v190, v70
    v_exp_f32 v191, v71
    v_add_f32 v208, v184, v185
    v_add_f32 v208, v208, v186
    v_add_f32 v208, v208, v187
    v_add_f32 v208, v208, v188
    v_add_f32 v208, v208, v189
    v_add_f32 v208, v208, v190
    v_add_f32 v208, v208, v191
    v_cvt_pk_bf16_f32 v176, v184, v185
    v_cvt_pk_bf16_f32 v177, v186, v187
    v_cvt_pk_bf16_f32 v178, v188, v189
    v_cvt_pk_bf16_f32 v179, v190, v191
    v_exp_f32 v184, v72
    v_exp_f32 v185, v73
    v_exp_f32 v186, v74
    v_exp_f32 v187, v75
    v_exp_f32 v188, v76
    v_exp_f32 v189, v77
    v_exp_f32 v190, v78
    v_exp_f32 v191, v79
    v_add_f32 v208, v208, v184
    v_add_f32 v208, v208, v185
    v_add_f32 v208, v208, v186
    v_add_f32 v208, v208, v187
    v_add_f32 v208, v208, v188
    v_add_f32 v208, v208, v189
    v_add_f32 v208, v208, v190
    v_add_f32 v208, v208, v191
    v_cvt_pk_bf16_f32 v180, v184, v185
    v_cvt_pk_bf16_f32 v181, v186, v187
    v_cvt_pk_bf16_f32 v182, v188, v189
    v_cvt_pk_bf16_f32 v183, v190, v191
    s_mov_b32 s42, 0x43800000
    s_mov_b32 s43, 0
    s_nop 1
    s_setpc_b64 s[44:45]
L_rarebody_1_0:
    s_nop 15
    s_nop 3
    v_max3_f32 v211, v80, v81, v82
    v_max3_f32 v211, v211, v83, v84
    v_max3_f32 v211, v211, v85, v86
    v_max3_f32 v211, v211, v87, v88
    v_max3_f32 v211, v211, v89, v90
    v_max3_f32 v211, v211, v91, v92
    v_max3_f32 v211, v211, v93, v94
    v_max_f32 v211, v211, v95
    v_mov_b32 v212, v211
    s_nop 1
    v_permlane32_swap_b32 v211, v212
    v_max3_f32 v213, v211, v212, s43
    v_max_f32 v211, 0, v213
    v_exp_f32_e64 v214, -v211
    v_sub_f32 v96, v96, v213
    v_sub_f32 v97, v97, v213
    v_sub_f32 v98, v98, v213
    v_sub_f32 v99, v99, v213
    v_sub_f32 v100, v100, v213
    v_sub_f32 v101, v101, v213
    v_sub_f32 v102, v102, v213
    v_sub_f32 v103, v103, v213
    v_sub_f32 v104, v104, v213
    v_sub_f32 v105, v105, v213
    v_sub_f32 v106, v106, v213
    v_sub_f32 v107, v107, v213
    v_sub_f32 v108, v108, v213
    v_sub_f32 v109, v109, v213
    v_sub_f32 v110, v110, v213
    v_sub_f32 v111, v111, v213
    v_sub_f32 v80, v80, v213
    v_sub_f32 v81, v81, v213
    v_sub_f32 v82, v82, v213
    v_sub_f32 v83, v83, v213
    v_sub_f32 v84, v84, v213
    v_sub_f32 v85, v85, v213
    v_sub_f32 v86, v86, v213
    v_sub_f32 v87, v87, v213
    v_sub_f32 v88, v88, v213
    v_sub_f32 v89, v89, v213
    v_sub_f32 v90, v90, v213
    v_sub_f32 v91, v91, v213
    v_sub_f32 v92, v92, v213
    v_sub_f32 v93, v93, v213
    v_sub_f32 v94, v94, v213
    v_sub_f32 v95, v95, v213
    s_cmp_lg_u32 s43, 0
    s_cbranch_scc1 L_norescale_69
    v_mul_f32 v207, v207, v214
    v_mul_f32 v0, v0, v214
    v_mul_f32 v1, v1, v214
    v_mul_f32 v2, v2, v214
    v_mul_f32 v3, v3, v214
    v_mul_f32 v4, v4, v214
    v_mul_f32 v5, v5, v214
    v_mul_f32 v6, v6, v214
    v_mul_f32 v7, v7, v214
    v_mul_f32 v8, v8, v214
    v_mul_f32 v9, v9, v214
    v_mul_f32 v10, v10, v214
    v_mul_f32 v11, v11, v214
    v_mul_f32 v12, v12, v214
    v_mul_f32 v13, v13, v214
    v_mul_f32 v14, v14, v214
    v_mul_f32 v15, v15, v214
    v_mul_f32 v16, v16, v214
    v_mul_f32 v17, v17, v214
    v_mul_f32 v18, v18, v214
    v_mul_f32 v19, v19, v214
    v_mul_f32 v20, v20, v214
    v_mul_f32 v21, v21, v214
    v_mul_f32 v22, v22, v214
    v_mul_f32 v23, v23, v214
    v_mul_f32 v24, v24, v214
    v_mul_f32 v25, v25, v214
    v_mul_f32 v26, v26, v214
    v_mul_f32 v27, v27, v214
    v_mul_f32 v28, v28, v214
    v_mul_f32 v29, v29, v214
    v_mul_f32 v30, v30, v214
    v_mul_f32 v31, v31, v214
    v_mul_f32 v32, v32, v214
    v_mul_f32 v33, v33, v214
    v_mul_f32 v34, v34, v214
    v_mul_f32 v35, v35, v214
    v_mul_f32 v36, v36, v214
    v_mul_f32 v37, v37, v214
    v_mul_f32 v38, v38, v214
    v_mul_f32 v39, v39, v214
    v_mul_f32 v40, v40, v214
    v_mul_f32 v41, v41, v214
    v_mul_f32 v42, v42, v214
    v_mul_f32 v43, v43, v214
    v_mul_f32 v44, v44, v214
    v_mul_f32 v45, v45, v214
    v_mul_f32 v46, v46, v214
    v_mul_f32 v47, v47, v214
    v_mul_f32 v48, v48, v214
    v_mul_f32 v49, v49, v214
    v_mul_f32 v50, v50, v214
    v_mul_f32 v51, v51, v214
    v_mul_f32 v52, v52, v214
    v_mul_f32 v53, v53, v214
    v_mul_f32 v54, v54, v214
    v_mul_f32 v55, v55, v214
    v_mul_f32 v56, v56, v214
    v_mul_f32 v57, v57, v214
    v_mul_f32 v58, v58, v214
    v_mul_f32 v59, v59, v214
    v_mul_f32 v60, v60, v214
    v_mul_f32 v61, v61, v214
    v_mul_f32 v62, v62, v214
    v_mul_f32 v63, v63, v214
L_norescale_69:
    v_exp_f32 v184, v80
    v_exp_f32 v185, v81
    v_exp_f32 v186, v82
    v_exp_f32 v187, v83
    v_exp_f32 v188, v84
    v_exp_f32 v189, v85
    v_exp_f32 v190, v86
    v_exp_f32 v191, v87
    v_add_f32 v208, v184, v185
    v_add_f32 v208, v208, v186
    v_add_f32 v208, v208, v187
    v_add_f32 v208, v208, v188
    v_add_f32 v208, v208, v189
    v_add_f32 v208, v208, v190
    v_add_f32 v208, v208, v191
    v_cvt_pk_bf16_f32 v176, v184, v185
    v_cvt_pk_bf16_f32 v177, v186, v187
    v_cvt_pk_bf16_f32 v178, v188, v189
    v_cvt_pk_bf16_f32 v179, v190, v191
    v_exp_f32 v184, v88
    v_exp_f32 v185, v89
    v_exp_f32 v186, v90
    v_exp_f32 v187, v91
    v_exp_f32 v188, v92
    v_exp_f32 v189, v93
    v_exp_f32 v190, v94
    v_exp_f32 v191, v95
    v_add_f32 v208, v208, v184
    v_add_f32 v208, v208, v185
    v_add_f32 v208, v208, v186
    v_add_f32 v208, v208, v187
    v_add_f32 v208, v208, v188
    v_add_f32 v208, v208, v189
    v_add_f32 v208, v208, v190
    v_add_f32 v208, v208, v191
    v_cvt_pk_bf16_f32 v180, v184, v185
    v_cvt_pk_bf16_f32 v181, v186, v187
    v_cvt_pk_bf16_f32 v182, v188, v189
    v_cvt_pk_bf16_f32 v183, v190, v191
    s_mov_b32 s42, 0x43800000
    s_mov_b32 s43, 0
    s_nop 1
    s_setpc_b64 s[44:45]
L_rarebody_1_1:
    s_nop 15
    s_nop 3
    v_max3_f32 v211, v80, v81, v82
    v_max3_f32 v211, v211, v83, v84
    v_max3_f32 v211, v211, v85, v86
    v_max3_f32 v211, v211, v87, v88
    v_max3_f32 v211, v211, v89, v90
    v_max3_f32 v211, v211, v91, v92
    v_max3_f32 v211, v211, v93, v94
    v_max_f32 v211, v211, v95
    v_mov_b32 v212, v211
    s_nop 1
    v_permlane32_swap_b32 v211, v212
    v_max3_f32 v213, v211, v212, s43
    v_max_f32 v211, 0, v213
    v_exp_f32_e64 v214, -v211
    v_sub_f32 v96, v96, v213
    v_sub_f32 v97, v97, v213
    v_sub_f32 v98, v98, v213
    v_sub_f32 v99, v99, v213
    v_sub_f32 v100, v100, v213
    v_sub_f32 v101, v101, v213
    v_sub_f32 v102, v102, v213
    v_sub_f32 v103, v103, v213
    v_sub_f32 v104, v104, v213
    v_sub_f32 v105, v105, v213
    v_sub_f32 v106, v106, v213
    v_sub_f32 v107, v107, v213
    v_sub_f32 v108, v108, v213
    v_sub_f32 v109, v109, v213
    v_sub_f32 v110, v110, v213
    v_sub_f32 v111, v111, v213
    v_sub_f32 v80, v80, v213
    v_sub_f32 v81, v81, v213
    v_sub_f32 v82, v82, v213
    v_sub_f32 v83, v83, v213
    v_sub_f32 v84, v84, v213
    v_sub_f32 v85, v85, v213
    v_sub_f32 v86, v86, v213
    v_sub_f32 v87, v87, v213
    v_sub_f32 v88, v88, v213
    v_sub_f32 v89, v89, v213
    v_sub_f32 v90, v90, v213
    v_sub_f32 v91, v91, v213
    v_sub_f32 v92, v92, v213
    v_sub_f32 v93, v93, v213
    v_sub_f32 v94, v94, v213
    v_sub_f32 v95, v95, v213
    v_sub_f32 v64, v64, v213
    v_sub_f32 v65, v65, v213
    v_sub_f32 v66, v66, v213
    v_sub_f32 v67, v67, v213
    v_sub_f32 v68, v68, v213
    v_sub_f32 v69, v69, v213
    v_sub_f32 v70, v70, v213
    v_sub_f32 v71, v71, v213
    v_sub_f32 v72, v72, v213
    v_sub_f32 v73, v73, v213
    v_sub_f32 v74, v74, v213
    v_sub_f32 v75, v75, v213
    v_sub_f32 v76, v76, v213
    v_sub_f32 v77, v77, v213
    v_sub_f32 v78, v78, v213
    v_sub_f32 v79, v79, v213
    s_cmp_lg_u32 s43, 0
    s_cbranch_scc1 L_norescale_70
    v_mul_f32 v207, v207, v214
    v_mul_f32 v0, v0, v214
    v_mul_f32 v1, v1, v214
    v_mul_f32 v2, v2, v214
    v_mul_f32 v3, v3, v214
    v_mul_f32 v4, v4, v214
    v_mul_f32 v5, v5, v214
    v_mul_f32 v6, v6, v214
    v_mul_f32 v7, v7, v214
    v_mul_f32 v8, v8, v214
    v_mul_f32 v9, v9, v214
    v_mul_f32 v10, v10, v214
    v_mul_f32 v11, v11, v214
    v_mul_f32 v12, v12, v214
    v_mul_f32 v13, v13, v214
    v_mul_f32 v14, v14, v214
    v_mul_f32 v15, v15, v214
    v_mul_f32 v16, v16, v214
    v_mul_f32 v17, v17, v214
    v_mul_f32 v18, v18, v214
    v_mul_f32 v19, v19, v214
    v_mul_f32 v20, v20, v214
    v_mul_f32 v21, v21, v214
    v_mul_f32 v22, v22, v214
    v_mul_f32 v23, v23, v214
    v_mul_f32 v24, v24, v214
    v_mul_f32 v25, v25, v214
    v_mul_f32 v26, v26, v214
    v_mul_f32 v27, v27, v214
    v_mul_f32 v28, v28, v214
    v_mul_f32 v29, v29, v214
    v_mul_f32 v30, v30, v214
    v_mul_f32 v31, v31, v214
    v_mul_f32 v32, v32, v214
    v_mul_f32 v33, v33, v214
    v_mul_f32 v34, v34, v214
    v_mul_f32 v35, v35, v214
    v_mul_f32 v36, v36, v214
    v_mul_f32 v37, v37, v214
    v_mul_f32 v38, v38, v214
    v_mul_f32 v39, v39, v214
    v_mul_f32 v40, v40, v214
    v_mul_f32 v41, v41, v214
    v_mul_f32 v42, v42, v214
    v_mul_f32 v43, v43, v214
    v_mul_f32 v44, v44, v214
    v_mul_f32 v45, v45, v214
    v_mul_f32 v46, v46, v214
    v_mul_f32 v47, v47, v214
    v_mul_f32 v48, v48, v214
    v_mul_f32 v49, v49, v214
    v_mul_f32 v50, v50, v214
    v_mul_f32 v51, v51, v214
    v_mul_f32 v52, v52, v214
    v_mul_f32 v53, v53, v214
    v_mul_f32 v54, v54, v214
    v_mul_f32 v55, v55, v214
    v_mul_f32 v56, v56, v214
    v_mul_f32 v57, v57, v214
    v_mul_f32 v58, v58, v214
    v_mul_f32 v59, v59, v214
    v_mul_f32 v60, v60, v214
    v_mul_f32 v61, v61, v214
    v_mul_f32 v62, v62, v214
    v_mul_f32 v63, v63, v214
L_norescale_70:
    v_exp_f32 v184, v80
    v_exp_f32 v185, v81
    v_exp_f32 v186, v82
    v_exp_f32 v187, v83
    v_exp_f32 v188, v84
    v_exp_f32 v189, v85
    v_exp_f32 v190, v86
    v_exp_f32 v191, v87
    v_add_f32 v208, v184, v185
    v_add_f32 v208, v208, v186
    v_add_f32 v208, v208, v187
    v_add_f32 v208, v208, v188
    v_add_f32 v208, v208, v189
    v_add_f32 v208, v208, v190
    v_add_f32 v208, v208, v191
    v_cvt_pk_bf16_f32 v176, v184, v185
    v_cvt_pk_bf16_f32 v177, v186, v187
    v_cvt_pk_bf16_f32 v178, v188, v189
    v_cvt_pk_bf16_f32 v179, v190, v191
    v_exp_f32 v184, v88
    v_exp_f32 v185, v89
    v_exp_f32 v186, v90
    v_exp_f32 v187, v91
    v_exp_f32 v188, v92
    v_exp_f32 v189, v93
    v_exp_f32 v190, v94
    v_exp_f32 v191, v95
    v_add_f32 v208, v208, v184
    v_add_f32 v208, v208, v185
    v_add_f32 v208, v208, v186
    v_add_f32 v208, v208, v187
    v_add_f32 v208, v208, v188
    v_add_f32 v208, v208, v189
    v_add_f32 v208, v208, v190
    v_add_f32 v208, v208, v191
    v_cvt_pk_bf16_f32 v180, v184, v185
    v_cvt_pk_bf16_f32 v181, v186, v187
    v_cvt_pk_bf16_f32 v182, v188, v189
    v_cvt_pk_bf16_f32 v183, v190, v191
    s_mov_b32 s42, 0x43800000
    s_mov_b32 s43, 0
    s_nop 1
    s_setpc_b64 s[44:45]

.section .rodata,"a"
.p2align 6
.amdhsa_kernel standalone__softmax_full_causal__prompt_kernel
  .amdhsa_next_free_vgpr 228
  .amdhsa_next_free_sgpr 100
  .amdhsa_accum_offset 228
  .amdhsa_group_segment_fixed_size 0
  .amdhsa_kernarg_size 48
  .amdhsa_user_sgpr_count 2
  .amdhsa_user_sgpr_kernarg_segment_ptr 1
  .amdhsa_system_sgpr_workgroup_id_x 1
.end_amdhsa_kernel
```
